```python
import torch

def _softmax(x, axis=-1):
    return torch.softmax(x, dim=axis)
def _gelu(x):
    return torch.nn.functional.gelu(x, approximate="tanh")
def _silu(x):
    return torch.nn.functional.silu(x)
def _sigmoid(x):
    return torch.sigmoid(x)
def _layernorm(x, axis=-1, eps=1e-5):
    m = x.mean(dim=axis, keepdim=True)
    v = x.var(dim=axis, keepdim=True, unbiased=False)
    return (x - m) / torch.sqrt(v + eps)
def _scatter_add(tgt, idx, src, axis=0):
    return tgt.clone().index_add_(axis, idx, src)
def _segment_sum(src, seg, n):
    out = torch.zeros((n,) + src.shape[1:], dtype=src.dtype)
    return out.index_add_(0, seg, src)
def _pad(x, pw):
    flat = tuple(v for pair in reversed(pw) for v in pair)
    return torch.nn.functional.pad(x, flat)

kernel_name = 'gated_mix__ssm_conv_s5__dense_activation_relu__prompt'

def setup_inputs():

    _w = (lambda a: (lambda t: t.to(torch.bfloat16) if t.is_floating_point() else t)(torch.as_tensor(a)))
    def _A_setup():
        B, S, D = 1, 2048, 448
        P = D
        Lambda_re = -0.5 * (lambda _x: torch.exp(torch.as_tensor(_x)))((lambda *s: torch.randn(*s, dtype=torch.bfloat16) * 0.8)(P))
        Lambda_im = (lambda *s: torch.randn(*s, dtype=torch.bfloat16) * 0.8)(P) * 1.0
        B_re = (lambda *s: torch.randn(*s, dtype=torch.bfloat16) * 0.8)(P, D) * (D ** -0.5)
        B_im = (lambda *s: torch.randn(*s, dtype=torch.bfloat16) * 0.8)(P, D) * (D ** -0.5)
        C_re = (lambda *s: torch.randn(*s, dtype=torch.bfloat16) * 0.8)(D, P) * (P ** -0.5)
        C_im = (lambda *s: torch.randn(*s, dtype=torch.bfloat16) * 0.8)(D, P) * (P ** -0.5)
        log_dt = (lambda *s: torch.randn(*s, dtype=torch.bfloat16) * 0.8)(P) * 0.3 - 2.0
        Dskip = (lambda *s: torch.randn(*s, dtype=torch.bfloat16) * 0.8)(D)
        return {
            "x": _w((lambda *s: torch.randn(*s, dtype=torch.bfloat16) * 0.05)(B, S, D)),
            "Lambda_re": _w(Lambda_re),
            "Lambda_im": _w(Lambda_im),
            "B_re": _w(B_re),
            "B_im": _w(B_im),
            "C_re": _w(C_re),
            "C_im": _w(C_im),
            "log_dt": _w(log_dt),
            "Dskip": _w(Dskip),
        }
    _A_in = _A_setup()

    def _B_setup():
        B, S, D, Dff = 1, 2048, 448, 1792
        return {
            "x": _w((lambda *s: torch.randn(*s, dtype=torch.bfloat16) * 0.05)(B, S, D)),
            "w1": _w((lambda *s: torch.randn(*s, dtype=torch.bfloat16) * 0.05)(D, Dff)),
            "w2": _w((lambda *s: torch.randn(*s, dtype=torch.bfloat16) * 0.05)(Dff, D)),
        }
    _B_in = _B_setup()

    return {
        "A_x": _A_in["x"],
        "A_Lambda_re": _A_in["Lambda_re"],
        "A_Lambda_im": _A_in["Lambda_im"],
        "A_B_re": _A_in["B_re"],
        "A_B_im": _A_in["B_im"],
        "A_C_re": _A_in["C_re"],
        "A_C_im": _A_in["C_im"],
        "A_log_dt": _A_in["log_dt"],
        "A_Dskip": _A_in["Dskip"],
        "B_x": _B_in["x"],
        "B_w1": _B_in["w1"],
        "B_w2": _B_in["w2"],
        "gate_w": _w((lambda *s: torch.randn(*s, dtype=torch.bfloat16) * 0.05)(448) * 16.0),
    }

def reference(A_x, A_Lambda_re, A_Lambda_im, A_B_re, A_B_im, A_C_re, A_C_im, A_log_dt, A_Dskip, B_x, B_w1, B_w2, gate_w):
    def _A_ref(x, Lambda_re, Lambda_im, B_re, B_im, C_re, C_im, log_dt, Dskip):
        Bsz, L, H = x.shape
        Lam = Lambda_re + 1j * Lambda_im
        Bmat = B_re + 1j * B_im
        Cmat = C_re + 1j * C_im
        dt = torch.exp(log_dt)
        Lam_bar = torch.exp(dt * Lam)
        B_bar = ((Lam_bar - 1.0) / Lam)[:, None] * Bmat
        Bu = torch.einsum("bld,pd->blp", x + 0j, B_bar)
        h = torch.zeros_like(Bu[:, 0, :])
        hs = []
        for t in range(L):
            h = Lam_bar[None, :] * h + Bu[:, t, :]
            hs.append(h)
        hseq = torch.stack(hs, 1)
        y = 2.0 * torch.einsum("blp,dp->bld", hseq, Cmat).real + x * Dskip[None, None, :]
        return y

    def _B_ref(x, w1, w2):
        h = torch.einsum("bsd,df->bsf", x, w1)
        zero = torch.zeros_like(h)
        h = torch.maximum(h, zero)
        return torch.einsum("bsf,fd->bsd", h, w2)

    x = A_x
    g = _sigmoid((x * gate_w).sum(-1, keepdims=True))
    a = _A_ref(x, A_Lambda_re, A_Lambda_im, A_B_re, A_B_im, A_C_re, A_C_im, A_log_dt, A_Dskip)
    b = _B_ref(x, B_w1, B_w2)
    return g * a + (1 - g) * b
```

```asm
; @launch grid=(256,1,1) block=(512,1,1) lds=163840
.amdgcn_target "amdgcn-amd-amdhsa--gfx950"
.text
.globl gated_mix__ssm_conv_s5__dense_activation_relu__prompt_kernel
.p2align 8
.type gated_mix__ssm_conv_s5__dense_activation_relu__prompt_kernel,@function
gated_mix__ssm_conv_s5__dense_activation_relu__prompt_kernel:
    s_getpc_b64 s[52:53]
    s_cmp_ge_u32 s2, 256
    s_cbranch_scc1 L_exit
    s_load_dwordx2 s[4:5], s[0:1], 0
    s_load_dwordx2 s[16:17], s[0:1], 80
    s_load_dwordx2 s[8:9], s[0:1], 24
    s_load_dwordx2 s[12:13], s[0:1], 32
    v_lshrrev_b32 v1, 6, v0
    s_lshr_b32 s63, s2, 3
    s_lshl_b32 s79, s63, 10
    v_readfirstlane_b32 s3, v1
    v_lshl_add_u32 v3, v1, 7, s79
    v_min_u32 v3, L_end-gated_mix__ssm_conv_s5__dense_activation_relu__prompt_kernel-1032, v3
    global_load_dword v11, v3, s[52:53] offset:1024
    v_and_b32 v2, 63, v0
    s_and_b32 s79, s2, 3
    s_mul_i32 s79, s79, 28
    s_mov_b32 s6, 1835008
    s_mov_b32 s7, 0x20000
    s_mov_b32 s18, 1605632
    s_mov_b32 s19, 0x20000
    s_mov_b32 s10, 401408
    s_mov_b32 s11, 0x20000
    s_mov_b32 s14, 401408
    s_mov_b32 s15, 0x20000
    s_and_b32 s62, s3, 3
    s_cmp_ge_u32 s2, 224
    s_cbranch_scc1 L_H
    s_add_u32 s79, s79, s63
    s_lshr_b32 s61, s79, 4
    s_and_b32 s60, s79, 15
    s_bfe_u32 s80, s2, 65538
    s_lshl_b32 s80, s80, 4
    s_add_u32 s60, s60, s80
    s_lshl_b32 s71, s62, 11
    s_mov_b32 s54, 0x10654321
    s_mov_b32 s55, 0x00065432
    s_lshl_b32 s79, s61, 2
    s_lshr_b64 s[54:55], s[54:55], s79
    s_lshr_b32 s83, s62, 1
    s_and_b32 s84, s62, 1
    s_mov_b32 s51, 0
    s_cmp_ge_u32 s3, 4
    s_cbranch_scc1 L_S
    s_lshl_b32 s79, s62, 3
    s_lshr_b32 s79, 0x40381008, s79
    s_and_b32 s79, s79, 0xff
    s_load_dwordx2 s[44:45], s[0:1], s79
    s_load_dwordx2 s[20:21], s[0:1], 96
    v_and_b32 v1, 7, v2
    v_lshrrev_b32 v3, 4, v2
    v_xor_b32 v1, v1, v3
    s_lshl_b32 s80, s60, 4
    s_add_u32 s80, s80, s62
    s_mul_i32 s80, s80, 3584
    v_bfe_u32 v3, v2, 3, 2
    v_lshrrev_b32 v4, 5, v2
    v_lshl_add_u32 v3, v4, 4, v3
    v_mul_u32_u24 v3, 896, v3
    v_add_u32 v3, s80, v3
    v_lshl_add_u32 v240, v1, 4, v3
    v_xor_b32 v241, 64, v240
    v_add_u32 v241, 27648, v241
    s_lshl_b32 s64, s54, 7
    s_and_b32 s64, s64, 0x780
    s_lshl_b32 s81, s61, 2
    s_add_u32 s81, s81, s62
    s_mul_i32 s81, s81, 14336
    v_lshrrev_b32 v3, 3, v2
    v_mul_u32_u24 v3, 896, v3
    v_add_u32 v3, s81, v3
    v_lshl_add_u32 v242, v1, 4, v3
    v_xor_b32 v243, 64, v242
    v_add_u32 v243, 6144, v243
    s_mov_b32 s46, 896
    s_mov_b32 s47, 0x20000
    s_mov_b32 s22, 896
    s_mov_b32 s23, 0x20000
    v_and_b32 v6, 31, v2
    v_lshlrev_b32 v6, 2, v6
    s_add_u32 m0, s71, 0
    s_waitcnt lgkmcnt(0)
    buffer_load_dwordx4 v240, s[4:7], s64 offen lds
    buffer_load_dwordx4 v241, s[4:7], s64 offen offset:1024 lds
    s_lshl_b32 s80, s62, 8
    s_add_u32 m0, s80, 58368
    s_lshl_b32 s81, s61, 7
    buffer_load_dword v6, s[44:47], s81 offen lds
    s_add_u32 m0, s80, 59392
    s_nop 0
    buffer_load_dword v6, s[20:23], s64 offen lds
    s_add_u32 m0, s71, 65536
    s_nop 0
    buffer_load_dwordx4 v242, s[8:11], s64 offen lds
    buffer_load_dwordx4 v243, s[8:11], s64 offen offset:1024 lds
    s_add_u32 m0, s71, 73728
    s_nop 0
    buffer_load_dwordx4 v242, s[12:15], s64 offen lds
    buffer_load_dwordx4 v243, s[12:15], s64 offen offset:1024 lds
    s_load_dwordx2 s[36:37], s[0:1], 120
    s_load_dwordx2 s[24:25], s[0:1], 88
    s_load_dwordx2 s[28:29], s[0:1], 40
    s_load_dwordx2 s[32:33], s[0:1], 48
    s_branch L_F2
L_H:
    s_load_dwordx2 s[24:25], s[0:1], 88
    s_load_dwordx2 s[28:29], s[0:1], 40
    s_load_dwordx2 s[32:33], s[0:1], 48
    s_load_dwordx2 s[36:37], s[0:1], 120
    s_mov_b32 s26, 1605632
    s_mov_b32 s27, 0x20000
    s_mov_b32 s30, 401408
    s_mov_b32 s31, 0x20000
    s_mov_b32 s34, 401408
    s_mov_b32 s35, 0x20000
    s_lshr_b32 s60, s79, 4
    s_add_u32 s61, s79, 27
    s_lshr_b32 s61, s61, 4
    s_sub_u32 s61, s61, s60
    s_add_u32 s61, s61, 1
    s_sub_u32 s45, s63, 28
    s_lshl_b32 s80, s3, 2
    s_add_u32 s45, s45, s80
    s_cmp_eq_u32 s61, 2
    s_mov_b32 s44, 21846
    s_cselect_b32 s44, 32768, s44
    v_mul_u32_u24 v3, 3584, v2
    v_mul_u32_u24 v4, 896, v2
    s_mov_b32 s73, 1
    s_mov_b32 s47, s3
    s_waitcnt lgkmcnt(0)
L_Hp:
    s_bitcmp1_b32 s73, 0
    s_cselect_b32 s67, s60, 0
    s_cselect_b32 s68, s61, 7
    s_cselect_b32 s69, s44, 9363
    s_cselect_b32 s70, 32, 256
    s_cselect_b32 s80, 0, 3
    s_cselect_b32 s81, 0, 7
    s_lshl_b32 s64, s45, s80
    s_and_b32 s81, s81, s2
    s_add_u32 s64, s64, s81
    s_cmp_ge_u32 s73, 2
    s_cselect_b32 s71, 28, 0
    s_cselect_b32 s72, 42, 28
    s_mul_i32 s72, s72, s68
L_Hl:
    s_cmp_ge_u32 s64, s72
    s_cbranch_scc1 L_He
    s_mul_i32 s65, s64, s69
    s_lshr_b32 s65, s65, 16
    s_mul_i32 s80, s65, s68
    s_sub_u32 s66, s64, s80
    s_add_u32 s66, s66, s67
    s_cmp_lg_u32 s71, 0
    s_cbranch_scc1 L_H2
    s_mul_i32 s80, s65, 9363
    s_lshr_b32 s80, s80, 16
    s_mul_i32 s81, s80, 7
    s_sub_u32 s81, s65, s81
    s_mul_i32 s81, s81, 229376
    s_lshl_b32 s80, s80, 7
    s_add_u32 s81, s81, s80
    s_lshl_b32 s80, s66, 9
    s_add_u32 s81, s81, s80
    buffer_load_dword v11, v3, s[16:19], s81 offen
    s_branch L_Hn
L_H2:
    s_mul_i32 s80, s65, 10923
    s_lshr_b32 s80, s80, 16
    s_mul_i32 s81, s80, 6
    s_sub_u32 s65, s65, s81
    s_add_u32 s80, s80, s66
    s_add_u32 s80, s80, 1
    s_cmp_ge_u32 s80, 7
    s_cselect_b32 s81, 7, 0
    s_sub_u32 s80, s80, s81
    s_cmp_ge_u32 s65, 4
    s_cbranch_scc1 L_H3
    s_lshl_b32 s81, s66, 2
    s_add_u32 s81, s81, s65
    s_mul_i32 s81, s81, 57344
    s_lshl_b32 s80, s80, 7
    s_add_u32 s81, s81, s80
    buffer_load_dword v11, v4, s[24:27], s81 offen
    s_branch L_Hn
L_H3:
    s_mul_i32 s81, s80, 57344
    s_lshl_b32 s80, s66, 7
    s_add_u32 s81, s81, s80
    s_cmp_eq_u32 s65, 5
    s_cbranch_scc1 L_H4
    buffer_load_dword v11, v4, s[28:31], s81 offen
    s_branch L_Hn
L_H4:
    buffer_load_dword v11, v4, s[32:35], s81 offen
L_Hn:
    s_cmp_eq_u32 s47, 7
    s_cbranch_scc1 L_Hm
L_Hw:
    s_waitcnt vmcnt(0)
    s_add_u32 s64, s64, s70
    s_branch L_Hl
L_Hm:
    s_mov_b32 s47, 0
    s_and_b32 s48, s2, 7
    s_lshl_b32 s48, s48, 2
    s_add_u32 s48, s48, s63
    s_sub_u32 s48, s48, 28
    s_mul_i32 s80, s48, 21846
    s_lshr_b32 s80, s80, 16
    s_mul_i32 s80, s80, 32768
    s_mul_i32 s49, s48, 688128
    s_add_u32 s49, s49, s80
    s_add_u32 s49, s49, 2097152
    s_lshl_b32 s48, s48, 7
    s_add_u32 s48, s48, 131072
    s_load_dword s46, s[36:37], s48 glc
    s_load_dword s58, s[36:37], 0
    s_add_u32 s50, s36, s49
    s_addc_u32 s51, s37, 0
    s_load_dword s46, s[50:51], 0 glc
    s_load_dword s46, s[50:51], 8192 glc
    s_load_dword s46, s[50:51], 20480 glc
    s_load_dword s46, s[50:51], 28672 glc
    s_mov_b32 s52, -1
    s_mov_b32 s53, -1
    s_waitcnt lgkmcnt(0)
    s_memtime s[54:55]
    s_load_dword s46, s[50:51], 0 glc
    s_waitcnt lgkmcnt(0)
    s_memtime s[56:57]
    s_waitcnt lgkmcnt(0)
    s_sub_u32 s59, s56, s54
    s_min_u32 s52, s52, s59
    s_memtime s[54:55]
    s_load_dword s46, s[50:51], 8192 glc
    s_waitcnt lgkmcnt(0)
    s_memtime s[56:57]
    s_waitcnt lgkmcnt(0)
    s_sub_u32 s59, s56, s54
    s_min_u32 s53, s53, s59
    s_memtime s[54:55]
    s_load_dword s46, s[50:51], 20480 glc
    s_waitcnt lgkmcnt(0)
    s_memtime s[56:57]
    s_waitcnt lgkmcnt(0)
    s_sub_u32 s59, s56, s54
    s_min_u32 s52, s52, s59
    s_memtime s[54:55]
    s_load_dword s46, s[50:51], 28672 glc
    s_waitcnt lgkmcnt(0)
    s_memtime s[56:57]
    s_waitcnt lgkmcnt(0)
    s_sub_u32 s59, s56, s54
    s_min_u32 s53, s53, s59
    s_or_b32 s80, s58, 0x55555555
    s_add_u32 s80, s80, 1
    s_and_b32 s80, s80, 0xaaaaaaaa
    s_andn2_b32 s58, 0x55555555, s58
    s_or_b32 s58, s58, s80
    s_cmp_lt_u32 s53, s52
    s_cselect_b32 s80, 2147483648, 0
    s_xor_b32 s80, s80, s58
    v_mov_b32 v5, s80
    v_mov_b32 v6, s48
    global_store_dword v6, v5, s[36:37] offset:64 sc1
    s_branch L_Hw
L_He:
    s_add_u32 s73, s73, 1
    s_cmp_lt_u32 s73, 4
    s_cbranch_scc1 L_Hp
L_exit:
    s_endpgm
.p2align 12
L_F2:
    s_mov_b32 s38, 33554432
    s_mov_b32 s39, 0x20000
    s_mov_b32 s26, 1605632
    s_mov_b32 s27, 0x20000
    s_mov_b32 s30, 401408
    s_mov_b32 s31, 0x20000
    s_mov_b32 s34, 401408
    s_mov_b32 s35, 0x20000
    s_mov_b32 s3, 0x00010001
    s_mov_b32 s85, 0x07060302
    s_mul_i32 s80, s60, 21846
    s_lshr_b32 s80, s80, 16
    s_mul_i32 s80, s80, 32768
    s_mul_i32 s79, s60, 688128
    s_add_u32 s79, s79, s80
    s_add_u32 s79, s79, 2097152
    s_add_u32 s79, s79, s71
    v_lshl_add_u32 v239, v2, 4, s79
    s_waitcnt lgkmcnt(0)
    s_load_dword s58, s[36:37], 0
    s_lshl_b32 s65, s54, 3
    s_and_b32 s65, s65, 0x780
    s_lshr_b32 s66, s54, 1
    s_and_b32 s66, s66, 0x780
    s_lshr_b32 s67, s54, 5
    s_and_b32 s67, s67, 0x780
    s_lshr_b32 s68, s54, 9
    s_and_b32 s68, s68, 0x780
    s_lshr_b32 s69, s54, 13
    s_and_b32 s69, s69, 0x780
    s_lshr_b32 s70, s54, 17
    s_and_b32 s70, s70, 0x780
    s_mul_i32 s72, s64, 1792
    s_mul_i32 s73, s65, 1792
    s_mul_i32 s74, s66, 1792
    s_mul_i32 s75, s67, 1792
    s_mul_i32 s76, s68, 1792
    s_mul_i32 s77, s69, 1792
    s_mul_i32 s78, s70, 1792
    v_and_b32 v4, 7, v2
    v_bfe_u32 v5, v2, 4, 1
    v_lshlrev_b32 v5, 2, v5
    v_xor_b32 v4, v4, v5
    v_lshrrev_b32 v3, 3, v2
    v_mul_u32_u24 v3, 3584, v3
    s_mul_i32 s80, s62, 57344
    s_lshl_b32 s81, s61, 9
    s_add_u32 s80, s80, s81
    v_add_u32 v3, s80, v3
    v_lshl_add_u32 v244, v4, 4, v3
    v_add_u32 v245, 27648, v244
    v_bfe_u32 v3, v2, 3, 2
    v_lshrrev_b32 v5, 5, v2
    v_lshl_add_u32 v3, v5, 3, v3
    v_mul_u32_u24 v3, 896, v3
    s_lshl_b32 s80, s61, 4
    s_add_u32 s80, s80, s62
    s_mul_i32 s80, s80, 14336
    v_add_u32 v3, s80, v3
    v_lshl_add_u32 v246, v4, 4, v3
    v_add_u32 v247, 2560, v246
    s_mul_i32 s81, s61, 57216
    v_subrev_u32 v248, s81, v242
    v_subrev_u32 v249, s81, v243
    v_and_b32 v3, 31, v2
    v_lshlrev_b32 v3, 7, v3
    s_lshl_b32 s80, s83, 12
    v_add_u32 v3, s80, v3
    v_bfe_u32 v4, v2, 1, 3
    v_xor_b32 v4, v4, v5
    v_lshl_add_u32 v226, v4, 4, v3
    s_lshl_b32 s81, s84, 12
    s_sub_u32 s81, s81, s80
    s_add_u32 s81, s81, 65536
    v_xor_b32 v227, 32, v226
    v_xor_b32 v228, 64, v226
    v_xor_b32 v229, 96, v226
    v_add_u32 v218, s81, v226
    v_add_u32 v219, s81, v227
    v_add_u32 v220, s81, v228
    v_add_u32 v221, s81, v229
    v_add_u32 v222, 0x10000, v218
    v_add_u32 v223, 0x10000, v219
    v_add_u32 v224, 0x10000, v220
    v_add_u32 v225, 0x10000, v221
    v_lshrrev_b32 v3, 5, v2
    v_bfe_u32 v4, v2, 2, 2
    v_lshl_add_u32 v5, v3, 3, v4
    v_lshlrev_b32 v5, 7, v5
    v_bfe_u32 v6, v2, 3, 1
    v_bfe_u32 v7, v2, 4, 1
    v_and_b32 v9, 3, v2
    v_xor_b32 v8, s84, v6
    v_lshl_add_u32 v8, v8, 6, v5
    v_lshl_add_u32 v8, v7, 5, v8
    v_lshl_add_u32 v8, v9, 3, v8
    v_add_u32 v216, 65536, v8
    v_add_u32 v217, 131072, v8
    v_xor_b32 v8, s83, v6
    v_lshl_add_u32 v8, v8, 6, v5
    v_lshl_add_u32 v8, v7, 3, v8
    v_bfe_u32 v7, v2, 2, 1
    v_xor_b32 v7, v7, v9
    v_lshl_add_u32 v232, v7, 4, v8
    v_xor_b32 v233, 32, v232
    s_lshl_b32 s80, s83, 14
    v_lshl_add_u32 v231, v2, 4, s80
    s_lshl_b32 s80, s84, 11
    v_add_u32 v230, s80, v231
    v_and_b32 v4, 7, v2
    v_lshlrev_b32 v5, 7, v4
    v_xor_b32 v4, v4, v3
    v_lshl_add_u32 v5, v4, 4, v5
    v_bfe_u32 v6, v2, 3, 2
    v_lshl_add_u32 v8, v6, 10, v5
    s_lshl_b32 s80, s62, 12
    s_add_u32 s80, s80, 65536
    v_add_u32 v238, s80, v8
    s_lshl_b32 s81, s60, 2
    s_add_u32 s81, s81, s62
    s_min_u32 s81, s81, 111
    s_mul_i32 s79, s61, 112
    s_add_u32 s81, s81, s79
    s_lshl_b32 s81, s81, 9
    v_lshrrev_b32 v9, 4, v2
    v_lshlrev_b32 v9, 7, v9
    buffer_load_dword v11, v9, s[8:11], s81 offen
    buffer_load_dword v11, v9, s[12:15], s81 offen
    s_add_u32 m0, s71, 8192
    s_nop 0
    buffer_load_dwordx4 v240, s[4:7], s65 offen lds
    buffer_load_dwordx4 v241, s[4:7], s65 offen offset:1024 lds
    s_add_u32 m0, s71, 81920
    s_nop 0
    buffer_load_dwordx4 v242, s[8:11], s65 offen lds
    buffer_load_dwordx4 v243, s[8:11], s65 offen offset:1024 lds
    s_add_u32 m0, s71, 90112
    s_nop 0
    buffer_load_dwordx4 v242, s[12:15], s65 offen lds
    buffer_load_dwordx4 v243, s[12:15], s65 offen offset:1024 lds
    s_add_u32 m0, s71, 16384
    s_nop 0
    buffer_load_dwordx4 v240, s[4:7], s66 offen lds
    buffer_load_dwordx4 v241, s[4:7], s66 offen offset:1024 lds
    s_waitcnt lgkmcnt(0)
    s_or_b32 s80, s58, 0x55555555
    s_add_u32 s80, s80, 1
    s_and_b32 s80, s80, 0xaaaaaaaa
    s_andn2_b32 s58, 0x55555555, s58
    s_or_b32 s58, s58, s80
    v_and_b32 v5, 3, v2
    v_lshlrev_b32 v5, 3, v5
    v_lshrrev_b32 v5, v5, s58
    v_bfe_u32 v6, v5, 0, 1
    v_bfe_u32 v7, v5, 1, 1
    v_lshl_or_b32 v234, v7, 16, v6
    v_bfe_u32 v6, v5, 2, 1
    v_bfe_u32 v7, v5, 3, 1
    v_lshl_or_b32 v235, v7, 16, v6
    v_bfe_u32 v6, v5, 4, 1
    v_bfe_u32 v7, v5, 5, 1
    v_lshl_or_b32 v236, v7, 16, v6
    v_bfe_u32 v6, v5, 6, 1
    v_bfe_u32 v7, v5, 7, 1
    v_lshl_or_b32 v237, v7, 16, v6
    s_waitcnt vmcnt(10)
    s_barrier
    s_add_u32 m0, s71, 98304
    s_nop 0
    buffer_load_dwordx4 v242, s[8:11], s66 offen lds
    buffer_load_dwordx4 v243, s[8:11], s66 offen offset:1024 lds
    s_add_u32 m0, s71, 106496
    s_nop 0
    buffer_load_dwordx4 v242, s[12:15], s66 offen lds
    buffer_load_dwordx4 v243, s[12:15], s66 offen offset:1024 lds
    s_add_u32 m0, s71, 24576
    s_nop 0
    buffer_load_dwordx4 v240, s[4:7], s67 offen lds
    buffer_load_dwordx4 v241, s[4:7], s67 offen offset:1024 lds
    s_add_u32 m0, s71, 114688
    s_nop 0
    buffer_load_dwordx4 v242, s[8:11], s67 offen lds
    buffer_load_dwordx4 v243, s[8:11], s67 offen offset:1024 lds
    s_waitcnt vmcnt(10)
    s_barrier
    s_add_u32 m0, s71, 122880
    s_nop 0
    buffer_load_dwordx4 v242, s[12:15], s67 offen lds
    buffer_load_dwordx4 v243, s[12:15], s67 offen offset:1024 lds
    s_add_u32 m0, s71, 32768
    s_nop 0
    buffer_load_dwordx4 v240, s[4:7], s68 offen lds
    buffer_load_dwordx4 v241, s[4:7], s68 offen offset:1024 lds
    s_add_u32 m0, s71, 131072
    s_nop 0
    buffer_load_dwordx4 v242, s[8:11], s68 offen lds
    buffer_load_dwordx4 v243, s[8:11], s68 offen offset:1024 lds
    s_waitcnt vmcnt(10)
    s_barrier
    s_add_u32 m0, s71, 139264
    s_nop 0
    buffer_load_dwordx4 v242, s[12:15], s68 offen lds
    buffer_load_dwordx4 v243, s[12:15], s68 offen offset:1024 lds
    s_add_u32 m0, s71, 40960
    s_nop 0
    buffer_load_dwordx4 v240, s[4:7], s69 offen lds
    buffer_load_dwordx4 v241, s[4:7], s69 offen offset:1024 lds
    s_add_u32 m0, s71, 147456
    s_nop 0
    buffer_load_dwordx4 v242, s[8:11], s69 offen lds
    buffer_load_dwordx4 v243, s[8:11], s69 offen offset:1024 lds
    s_waitcnt vmcnt(10)
    s_barrier
    s_add_u32 m0, s71, 155648
    s_nop 0
    buffer_load_dwordx4 v242, s[12:15], s69 offen lds
    buffer_load_dwordx4 v243, s[12:15], s69 offen offset:1024 lds
    s_add_u32 m0, s71, 49152
    s_nop 0
    buffer_load_dwordx4 v240, s[4:7], s70 offen lds
    buffer_load_dwordx4 v241, s[4:7], s70 offen offset:1024 lds
    s_add_u32 m0, s71, 65536
    s_nop 0
    buffer_load_dwordx4 v242, s[8:11], s70 offen lds
    buffer_load_dwordx4 v243, s[8:11], s70 offen offset:1024 lds
    s_waitcnt vmcnt(10)
    s_barrier
    s_add_u32 m0, s71, 73728
    s_nop 0
    buffer_load_dwordx4 v242, s[12:15], s70 offen lds
    buffer_load_dwordx4 v243, s[12:15], s70 offen offset:1024 lds
    s_add_u32 m0, s71, 81920
    s_nop 0
    buffer_load_dwordx4 v244, s[16:19], s72 offen lds
    buffer_load_dwordx4 v245, s[16:19], s72 offen offset:1024 lds
    s_add_u32 m0, s71, 90112
    s_nop 0
    buffer_load_dwordx4 v244, s[16:19], s73 offen lds
    buffer_load_dwordx4 v245, s[16:19], s73 offen offset:1024 lds
    s_waitcnt vmcnt(10)
    s_barrier
    s_add_u32 m0, s71, 98304
    s_nop 0
    buffer_load_dwordx4 v244, s[16:19], s74 offen lds
    buffer_load_dwordx4 v245, s[16:19], s74 offen offset:1024 lds
    s_add_u32 m0, s71, 106496
    s_nop 0
    buffer_load_dwordx4 v244, s[16:19], s75 offen lds
    buffer_load_dwordx4 v245, s[16:19], s75 offen offset:1024 lds
    s_add_u32 m0, s71, 114688
    s_nop 0
    buffer_load_dwordx4 v244, s[16:19], s76 offen lds
    buffer_load_dwordx4 v245, s[16:19], s76 offen offset:1024 lds
    s_waitcnt vmcnt(10)
    s_barrier
    s_add_u32 m0, s71, 122880
    s_nop 0
    buffer_load_dwordx4 v244, s[16:19], s77 offen lds
    buffer_load_dwordx4 v245, s[16:19], s77 offen offset:1024 lds
    s_add_u32 m0, s71, 131072
    s_nop 0
    buffer_load_dwordx4 v244, s[16:19], s78 offen lds
    buffer_load_dwordx4 v245, s[16:19], s78 offen offset:1024 lds
    s_waitcnt vmcnt(10)
    s_barrier
    ds_read_b128 v[12:15], v226 offset:0
    ds_read_b64_tr_b16 v[172:173], v216 offset:16384
    ds_read_b64_tr_b16 v[174:175], v216 offset:16896
    ds_read_b128 v[16:19], v227 offset:0
    ds_read_b64_tr_b16 v[176:177], v216 offset:18432
    ds_read_b64_tr_b16 v[178:179], v216 offset:18944
    ds_read_b128 v[20:23], v228 offset:0
    ds_read_b64_tr_b16 v[180:181], v216 offset:20480
    ds_read_b64_tr_b16 v[182:183], v216 offset:20992
    ds_read_b128 v[24:27], v229 offset:0
    ds_read_b64_tr_b16 v[184:185], v216 offset:22528
    ds_read_b64_tr_b16 v[186:187], v216 offset:23040
    ds_read_b128 v[28:31], v226 offset:8192
    ds_read_b64_tr_b16 v[188:189], v216 offset:24576
    ds_read_b64_tr_b16 v[190:191], v216 offset:25088
    s_add_u32 m0, s71, 139264
    s_add_u32 s79, s72, 128
    buffer_load_dwordx4 v244, s[16:19], s79 offen lds
    s_waitcnt lgkmcnt(12)
    v_mfma_f32_32x32x16_bf16 v[124:139], v[172:175], v[12:15], 0
    s_waitcnt vmcnt(5)
    s_barrier
    ds_read_b128 v[32:35], v227 offset:8192
    ds_read_b64_tr_b16 v[172:173], v216 offset:26624
    ds_read_b64_tr_b16 v[174:175], v216 offset:27136
    buffer_load_dwordx4 v245, s[16:19], s79 offen offset:1024 lds
    s_waitcnt lgkmcnt(9)
    v_mfma_f32_32x32x16_bf16 v[124:139], v[176:179], v[16:19], v[124:139]
    ds_read_b128 v[36:39], v228 offset:8192
    ds_read_b64_tr_b16 v[176:177], v216 offset:28672
    ds_read_b64_tr_b16 v[178:179], v216 offset:29184
    s_add_u32 m0, s71, 147456
    s_add_u32 s79, s73, 128
    buffer_load_dwordx4 v244, s[16:19], s79 offen lds
    v_mfma_f32_32x32x16_bf16 v[124:139], v[180:183], v[20:23], v[124:139]
    ds_read_b128 v[40:43], v229 offset:8192
    ds_read_b64_tr_b16 v[180:181], v216 offset:30720
    ds_read_b64_tr_b16 v[182:183], v216 offset:31232
    buffer_load_dwordx4 v245, s[16:19], s79 offen offset:1024 lds
    s_waitcnt lgkmcnt(9)
    v_mfma_f32_32x32x16_bf16 v[124:139], v[184:187], v[24:27], v[124:139]
    ds_read_b128 v[44:47], v226 offset:16384
    ds_read_b64_tr_b16 v[184:185], v216 offset:32768
    ds_read_b64_tr_b16 v[186:187], v216 offset:33280
    s_add_u32 m0, s71, 155648
    s_add_u32 s79, s74, 128
    buffer_load_dwordx4 v244, s[16:19], s79 offen lds
    v_mfma_f32_32x32x16_bf16 v[124:139], v[188:191], v[28:31], v[124:139]
    ds_read_b128 v[48:51], v227 offset:16384
    ds_read_b64_tr_b16 v[188:189], v216 offset:34816
    ds_read_b64_tr_b16 v[190:191], v216 offset:35328
    s_waitcnt lgkmcnt(9)
    v_mfma_f32_32x32x16_bf16 v[124:139], v[172:175], v[32:35], v[124:139]
    ds_read_b128 v[52:55], v228 offset:16384
    ds_read_b64_tr_b16 v[172:173], v216 offset:36864
    ds_read_b64_tr_b16 v[174:175], v216 offset:37376
    buffer_load_dwordx4 v245, s[16:19], s79 offen offset:1024 lds
    v_mfma_f32_32x32x16_bf16 v[124:139], v[176:179], v[36:39], v[124:139]
    ds_read_b128 v[56:59], v229 offset:16384
    ds_read_b64_tr_b16 v[176:177], v216 offset:38912
    ds_read_b64_tr_b16 v[178:179], v216 offset:39424
    s_add_u32 m0, s71, 65536
    s_add_u32 s79, s75, 128
    s_waitcnt lgkmcnt(9)
    v_mfma_f32_32x32x16_bf16 v[124:139], v[180:183], v[40:43], v[124:139]
    ds_read_b128 v[60:63], v226 offset:24576
    ds_read_b64_tr_b16 v[180:181], v216 offset:40960
    ds_read_b64_tr_b16 v[182:183], v216 offset:41472
    buffer_load_dwordx4 v244, s[16:19], s79 offen lds
    v_mfma_f32_32x32x16_bf16 v[124:139], v[184:187], v[44:47], v[124:139]
    ds_read_b128 v[64:67], v227 offset:24576
    ds_read_b64_tr_b16 v[184:185], v216 offset:43008
    ds_read_b64_tr_b16 v[186:187], v216 offset:43520
    s_waitcnt lgkmcnt(9)
    v_mfma_f32_32x32x16_bf16 v[124:139], v[188:191], v[48:51], v[124:139]
    ds_read_b128 v[68:71], v228 offset:24576
    ds_read_b64_tr_b16 v[188:189], v216 offset:45056
    ds_read_b64_tr_b16 v[190:191], v216 offset:45568
    buffer_load_dwordx4 v245, s[16:19], s79 offen offset:1024 lds
    v_mfma_f32_32x32x16_bf16 v[124:139], v[172:175], v[52:55], v[124:139]
    ds_read_b128 v[72:75], v229 offset:24576
    ds_read_b64_tr_b16 v[172:173], v216 offset:47104
    ds_read_b64_tr_b16 v[174:175], v216 offset:47616
    s_add_u32 m0, s71, 73728
    s_add_u32 s79, s76, 128
    s_waitcnt lgkmcnt(9)
    v_mfma_f32_32x32x16_bf16 v[124:139], v[176:179], v[56:59], v[124:139]
    ds_read_b128 v[76:79], v226 offset:32768
    ds_read_b64_tr_b16 v[176:177], v216 offset:49152
    ds_read_b64_tr_b16 v[178:179], v216 offset:49664
    buffer_load_dwordx4 v244, s[16:19], s79 offen lds
    v_mfma_f32_32x32x16_bf16 v[124:139], v[180:183], v[60:63], v[124:139]
    ds_read_b128 v[80:83], v227 offset:32768
    ds_read_b64_tr_b16 v[180:181], v216 offset:51200
    ds_read_b64_tr_b16 v[182:183], v216 offset:51712
    s_waitcnt lgkmcnt(9)
    v_mfma_f32_32x32x16_bf16 v[124:139], v[184:187], v[64:67], v[124:139]
    ds_read_b128 v[84:87], v228 offset:32768
    ds_read_b64_tr_b16 v[184:185], v216 offset:53248
    ds_read_b64_tr_b16 v[186:187], v216 offset:53760
    buffer_load_dwordx4 v245, s[16:19], s79 offen offset:1024 lds
    v_mfma_f32_32x32x16_bf16 v[124:139], v[188:191], v[68:71], v[124:139]
    ds_read_b128 v[88:91], v229 offset:32768
    ds_read_b64_tr_b16 v[188:189], v216 offset:55296
    ds_read_b64_tr_b16 v[190:191], v216 offset:55808
    s_add_u32 m0, s71, 81920
    s_add_u32 s79, s77, 128
    s_waitcnt lgkmcnt(9)
    v_mfma_f32_32x32x16_bf16 v[124:139], v[172:175], v[72:75], v[124:139]
    s_waitcnt vmcnt(8)
    s_barrier
    ds_read_b128 v[92:95], v226 offset:40960
    ds_read_b64_tr_b16 v[172:173], v216 offset:57344
    ds_read_b64_tr_b16 v[174:175], v216 offset:57856
    buffer_load_dwordx4 v244, s[16:19], s79 offen lds
    v_mfma_f32_32x32x16_bf16 v[124:139], v[176:179], v[76:79], v[124:139]
    ds_read_b128 v[96:99], v227 offset:40960
    ds_read_b64_tr_b16 v[176:177], v216 offset:59392
    ds_read_b64_tr_b16 v[178:179], v216 offset:59904
    s_waitcnt lgkmcnt(9)
    v_mfma_f32_32x32x16_bf16 v[124:139], v[180:183], v[80:83], v[124:139]
    ds_read_b128 v[100:103], v228 offset:40960
    ds_read_b64_tr_b16 v[180:181], v216 offset:61440
    ds_read_b64_tr_b16 v[182:183], v216 offset:61952
    buffer_load_dwordx4 v245, s[16:19], s79 offen offset:1024 lds
    v_mfma_f32_32x32x16_bf16 v[124:139], v[184:187], v[84:87], v[124:139]
    ds_read_b128 v[104:107], v229 offset:40960
    ds_read_b64_tr_b16 v[184:185], v216 offset:63488
    ds_read_b64_tr_b16 v[186:187], v216 offset:64000
    s_add_u32 m0, s71, 90112
    s_add_u32 s79, s78, 128
    s_waitcnt lgkmcnt(9)
    v_mfma_f32_32x32x16_bf16 v[124:139], v[188:191], v[88:91], v[124:139]
    ds_read_b128 v[108:111], v226 offset:49152
    ds_read_b64_tr_b16 v[188:189], v217 offset:0
    ds_read_b64_tr_b16 v[190:191], v217 offset:512
    buffer_load_dwordx4 v244, s[16:19], s79 offen lds
    v_mfma_f32_32x32x16_bf16 v[124:139], v[172:175], v[92:95], v[124:139]
    ds_read_b128 v[112:115], v227 offset:49152
    ds_read_b64_tr_b16 v[172:173], v217 offset:2048
    ds_read_b64_tr_b16 v[174:175], v217 offset:2560
    s_waitcnt lgkmcnt(9)
    v_mfma_f32_32x32x16_bf16 v[124:139], v[176:179], v[96:99], v[124:139]
    ds_read_b128 v[116:119], v228 offset:49152
    ds_read_b64_tr_b16 v[176:177], v217 offset:4096
    ds_read_b64_tr_b16 v[178:179], v217 offset:4608
    buffer_load_dwordx4 v245, s[16:19], s79 offen offset:1024 lds
    v_mfma_f32_32x32x16_bf16 v[124:139], v[180:183], v[100:103], v[124:139]
    ds_read_b128 v[120:123], v229 offset:49152
    ds_read_b64_tr_b16 v[180:181], v217 offset:6144
    ds_read_b64_tr_b16 v[182:183], v217 offset:6656
    s_add_u32 m0, s71, 98304
    s_add_u32 s79, s72, 256
    s_waitcnt lgkmcnt(9)
    v_mfma_f32_32x32x16_bf16 v[124:139], v[184:187], v[104:107], v[124:139]
    ds_read_b64_tr_b16 v[184:185], v217 offset:8192
    buffer_load_dwordx4 v244, s[16:19], s79 offen lds
    v_mfma_f32_32x32x16_bf16 v[124:139], v[188:191], v[108:111], v[124:139]
    ds_read_b64_tr_b16 v[186:187], v217 offset:8704
    ds_read_b64_tr_b16 v[188:189], v217 offset:10240
    ds_read_b64_tr_b16 v[190:191], v217 offset:10752
    s_waitcnt lgkmcnt(7)
    v_mfma_f32_32x32x16_bf16 v[124:139], v[172:175], v[112:115], v[124:139]
    ds_read_b64_tr_b16 v[172:173], v217 offset:12288
    buffer_load_dwordx4 v245, s[16:19], s79 offen offset:1024 lds
    v_mfma_f32_32x32x16_bf16 v[124:139], v[176:179], v[116:119], v[124:139]
    ds_read_b64_tr_b16 v[174:175], v217 offset:12800
    ds_read_b64_tr_b16 v[176:177], v217 offset:14336
    ds_read_b64_tr_b16 v[178:179], v217 offset:14848
    s_add_u32 m0, s71, 106496
    s_add_u32 s79, s73, 256
    s_waitcnt lgkmcnt(6)
    v_mfma_f32_32x32x16_bf16 v[124:139], v[180:183], v[120:123], v[124:139]
    s_waitcnt vmcnt(6)
    s_barrier
    ds_read_b64_tr_b16 v[180:181], v217 offset:16384
    buffer_load_dwordx4 v244, s[16:19], s79 offen lds
    v_mfma_f32_32x32x16_bf16 v[140:155], v[184:187], v[12:15], 0
    ds_read_b64_tr_b16 v[182:183], v217 offset:16896
    ds_read_b64_tr_b16 v[184:185], v217 offset:18432
    ds_read_b64_tr_b16 v[186:187], v217 offset:18944
    s_waitcnt lgkmcnt(6)
    v_mfma_f32_32x32x16_bf16 v[140:155], v[188:191], v[16:19], v[140:155]
    ds_read_b64_tr_b16 v[188:189], v217 offset:20480
    ds_read_b64_tr_b16 v[190:191], v217 offset:20992
    buffer_load_dwordx4 v245, s[16:19], s79 offen offset:1024 lds
    v_mfma_f32_32x32x16_bf16 v[140:155], v[172:175], v[20:23], v[140:155]
    ds_read_b64_tr_b16 v[172:173], v217 offset:22528
    ds_read_b64_tr_b16 v[174:175], v217 offset:23040
    s_add_u32 m0, s71, 114688
    s_add_u32 s79, s74, 256
    v_max_f32 v124, 0, v124
    s_waitcnt lgkmcnt(6)
    v_mfma_f32_32x32x16_bf16 v[140:155], v[176:179], v[24:27], v[140:155]
    ds_read_b64_tr_b16 v[176:177], v217 offset:24576
    ds_read_b64_tr_b16 v[178:179], v217 offset:25088
    buffer_load_dwordx4 v244, s[16:19], s79 offen lds
    v_max_f32 v125, 0, v125
    v_cvt_pk_bf16_f32 v192, v124, v125
    v_mfma_f32_32x32x16_bf16 v[140:155], v[180:183], v[28:31], v[140:155]
    ds_read_b64_tr_b16 v[180:181], v217 offset:26624
    ds_read_b64_tr_b16 v[182:183], v217 offset:27136
    v_max_f32 v126, 0, v126
    v_max_f32 v127, 0, v127
    v_cvt_pk_bf16_f32 v193, v126, v127
    s_waitcnt lgkmcnt(6)
    v_mfma_f32_32x32x16_bf16 v[140:155], v[184:187], v[32:35], v[140:155]
    ds_read_b64_tr_b16 v[184:185], v217 offset:28672
    ds_read_b64_tr_b16 v[186:187], v217 offset:29184
    buffer_load_dwordx4 v245, s[16:19], s79 offen offset:1024 lds
    v_max_f32 v128, 0, v128
    v_max_f32 v129, 0, v129
    v_mfma_f32_32x32x16_bf16 v[140:155], v[188:191], v[36:39], v[140:155]
    ds_read_b64_tr_b16 v[188:189], v217 offset:30720
    ds_read_b64_tr_b16 v[190:191], v217 offset:31232
    s_add_u32 m0, s71, 122880
    s_add_u32 s79, s75, 256
    v_cvt_pk_bf16_f32 v194, v128, v129
    s_waitcnt lgkmcnt(6)
    v_mfma_f32_32x32x16_bf16 v[140:155], v[172:175], v[40:43], v[140:155]
    ds_read_b64_tr_b16 v[172:173], v216 offset:0
    ds_read_b64_tr_b16 v[174:175], v216 offset:512
    buffer_load_dwordx4 v244, s[16:19], s79 offen lds
    v_max_f32 v130, 0, v130
    v_max_f32 v131, 0, v131
    v_mfma_f32_32x32x16_bf16 v[140:155], v[176:179], v[44:47], v[140:155]
    ds_read_b64_tr_b16 v[176:177], v216 offset:2048
    ds_read_b64_tr_b16 v[178:179], v216 offset:2560
    v_cvt_pk_bf16_f32 v195, v130, v131
    v_max_f32 v132, 0, v132
    v_max_f32 v133, 0, v133
    s_waitcnt lgkmcnt(6)
    v_mfma_f32_32x32x16_bf16 v[140:155], v[180:183], v[48:51], v[140:155]
    ds_read_b64_tr_b16 v[180:181], v216 offset:4096
    ds_read_b64_tr_b16 v[182:183], v216 offset:4608
    buffer_load_dwordx4 v245, s[16:19], s79 offen offset:1024 lds
    v_cvt_pk_bf16_f32 v196, v132, v133
    v_max_f32 v134, 0, v134
    v_mfma_f32_32x32x16_bf16 v[140:155], v[184:187], v[52:55], v[140:155]
    ds_read_b64_tr_b16 v[184:185], v216 offset:6144
    ds_read_b64_tr_b16 v[186:187], v216 offset:6656
    s_add_u32 m0, s71, 131072
    s_add_u32 s79, s76, 256
    v_max_f32 v135, 0, v135
    s_waitcnt lgkmcnt(6)
    v_mfma_f32_32x32x16_bf16 v[140:155], v[188:191], v[56:59], v[140:155]
    ds_read_b64_tr_b16 v[188:189], v216 offset:8192
    ds_read_b64_tr_b16 v[190:191], v216 offset:8704
    buffer_load_dwordx4 v244, s[16:19], s79 offen lds
    v_cvt_pk_bf16_f32 v197, v134, v135
    v_max_f32 v136, 0, v136
    v_mfma_f32_32x32x16_bf16 v[140:155], v[172:175], v[60:63], v[140:155]
    ds_read_b64_tr_b16 v[172:173], v216 offset:10240
    ds_read_b64_tr_b16 v[174:175], v216 offset:10752
    v_max_f32 v137, 0, v137
    v_cvt_pk_bf16_f32 v198, v136, v137
    v_max_f32 v138, 0, v138
    s_waitcnt lgkmcnt(6)
    v_mfma_f32_32x32x16_bf16 v[140:155], v[176:179], v[64:67], v[140:155]
    ds_read_b64_tr_b16 v[176:177], v216 offset:12288
    ds_read_b64_tr_b16 v[178:179], v216 offset:12800
    buffer_load_dwordx4 v245, s[16:19], s79 offen offset:1024 lds
    v_max_f32 v139, 0, v139
    v_cvt_pk_bf16_f32 v199, v138, v139
    v_mfma_f32_32x32x16_bf16 v[140:155], v[180:183], v[68:71], v[140:155]
    ds_read_b64_tr_b16 v[180:181], v216 offset:14336
    ds_read_b64_tr_b16 v[182:183], v216 offset:14848
    s_add_u32 m0, s71, 139264
    s_add_u32 s79, s77, 256
    s_waitcnt lgkmcnt(6)
    v_mfma_f32_32x32x16_bf16 v[140:155], v[184:187], v[72:75], v[140:155]
    s_waitcnt vmcnt(10)
    s_barrier
    ds_read_b64_tr_b16 v[184:185], v216 offset:16384
    buffer_load_dwordx4 v244, s[16:19], s79 offen lds
    v_mfma_f32_32x32x16_bf16 v[140:155], v[188:191], v[76:79], v[140:155]
    ds_read_b64_tr_b16 v[186:187], v216 offset:16896
    ds_read_b64_tr_b16 v[188:189], v216 offset:18432
    ds_read_b64_tr_b16 v[190:191], v216 offset:18944
    s_waitcnt lgkmcnt(6)
    v_mfma_f32_32x32x16_bf16 v[140:155], v[172:175], v[80:83], v[140:155]
    ds_read_b64_tr_b16 v[172:173], v216 offset:20480
    buffer_load_dwordx4 v245, s[16:19], s79 offen offset:1024 lds
    v_mfma_f32_32x32x16_bf16 v[140:155], v[176:179], v[84:87], v[140:155]
    ds_read_b64_tr_b16 v[174:175], v216 offset:20992
    ds_read_b64_tr_b16 v[176:177], v216 offset:22528
    ds_read_b64_tr_b16 v[178:179], v216 offset:23040
    s_add_u32 m0, s71, 147456
    s_add_u32 s79, s78, 256
    s_waitcnt lgkmcnt(6)
    v_mfma_f32_32x32x16_bf16 v[140:155], v[180:183], v[88:91], v[140:155]
    ds_read_b64_tr_b16 v[180:181], v216 offset:24576
    buffer_load_dwordx4 v244, s[16:19], s79 offen lds
    v_mfma_f32_32x32x16_bf16 v[140:155], v[184:187], v[92:95], v[140:155]
    ds_read_b64_tr_b16 v[182:183], v216 offset:25088
    ds_read_b64_tr_b16 v[184:185], v216 offset:26624
    ds_read_b64_tr_b16 v[186:187], v216 offset:27136
    s_waitcnt lgkmcnt(6)
    v_mfma_f32_32x32x16_bf16 v[140:155], v[188:191], v[96:99], v[140:155]
    ds_read_b64_tr_b16 v[188:189], v216 offset:28672
    buffer_load_dwordx4 v245, s[16:19], s79 offen offset:1024 lds
    v_mfma_f32_32x32x16_bf16 v[140:155], v[172:175], v[100:103], v[140:155]
    ds_read_b64_tr_b16 v[190:191], v216 offset:29184
    ds_read_b64_tr_b16 v[172:173], v216 offset:30720
    ds_read_b64_tr_b16 v[174:175], v216 offset:31232
    s_add_u32 m0, s71, 155648
    s_add_u32 s79, s72, 384
    s_waitcnt lgkmcnt(6)
    v_mfma_f32_32x32x16_bf16 v[140:155], v[176:179], v[104:107], v[140:155]
    s_waitcnt vmcnt(8)
    s_barrier
    ds_read_b64_tr_b16 v[176:177], v216 offset:32768
    buffer_load_dwordx4 v244, s[16:19], s79 offen lds
    v_mfma_f32_32x32x16_bf16 v[140:155], v[180:183], v[108:111], v[140:155]
    ds_read_b64_tr_b16 v[178:179], v216 offset:33280
    ds_read_b64_tr_b16 v[180:181], v216 offset:34816
    ds_read_b64_tr_b16 v[182:183], v216 offset:35328
    s_waitcnt lgkmcnt(6)
    v_mfma_f32_32x32x16_bf16 v[140:155], v[184:187], v[112:115], v[140:155]
    ds_read_b64_tr_b16 v[184:185], v216 offset:36864
    buffer_load_dwordx4 v245, s[16:19], s79 offen offset:1024 lds
    v_mfma_f32_32x32x16_bf16 v[140:155], v[188:191], v[116:119], v[140:155]
    ds_read_b64_tr_b16 v[186:187], v216 offset:37376
    ds_read_b64_tr_b16 v[188:189], v216 offset:38912
    ds_read_b64_tr_b16 v[190:191], v216 offset:39424
    s_add_u32 m0, s71, 65536
L_pad0:
    s_cmp_eq_u32 s51, 1
    s_cbranch_scc1 L_pad4
    s_add_u32 s79, s73, 384
    s_waitcnt lgkmcnt(6)
    v_mfma_f32_32x32x16_bf16 v[140:155], v[172:175], v[120:123], v[140:155]
    ds_read_b64_tr_b16 v[172:173], v216 offset:40960
    buffer_load_dwordx4 v244, s[16:19], s79 offen lds
    v_mfma_f32_32x32x16_bf16 v[156:171], v[176:179], v[12:15], 0
    ds_read_b64_tr_b16 v[174:175], v216 offset:41472
    ds_read_b64_tr_b16 v[176:177], v216 offset:43008
    ds_read_b64_tr_b16 v[178:179], v216 offset:43520
    s_waitcnt lgkmcnt(6)
    v_mfma_f32_32x32x16_bf16 v[156:171], v[180:183], v[16:19], v[156:171]
    ds_read_b64_tr_b16 v[180:181], v216 offset:45056
    ds_read_b64_tr_b16 v[182:183], v216 offset:45568
    buffer_load_dwordx4 v245, s[16:19], s79 offen offset:1024 lds
    v_mfma_f32_32x32x16_bf16 v[156:171], v[184:187], v[20:23], v[156:171]
    ds_read_b64_tr_b16 v[184:185], v216 offset:47104
    ds_read_b64_tr_b16 v[186:187], v216 offset:47616
    s_add_u32 m0, s71, 73728
    s_add_u32 s79, s74, 384
    v_max_f32 v140, 0, v140
    s_waitcnt lgkmcnt(6)
    v_mfma_f32_32x32x16_bf16 v[156:171], v[188:191], v[24:27], v[156:171]
    ds_read_b64_tr_b16 v[188:189], v216 offset:49152
    ds_read_b64_tr_b16 v[190:191], v216 offset:49664
    buffer_load_dwordx4 v244, s[16:19], s79 offen lds
    v_max_f32 v141, 0, v141
    v_cvt_pk_bf16_f32 v200, v140, v141
    v_mfma_f32_32x32x16_bf16 v[156:171], v[172:175], v[28:31], v[156:171]
    ds_read_b64_tr_b16 v[172:173], v216 offset:51200
    ds_read_b64_tr_b16 v[174:175], v216 offset:51712
    v_max_f32 v142, 0, v142
    v_max_f32 v143, 0, v143
    v_cvt_pk_bf16_f32 v201, v142, v143
    s_waitcnt lgkmcnt(6)
    v_mfma_f32_32x32x16_bf16 v[156:171], v[176:179], v[32:35], v[156:171]
    ds_read_b64_tr_b16 v[176:177], v216 offset:53248
    ds_read_b64_tr_b16 v[178:179], v216 offset:53760
    buffer_load_dwordx4 v245, s[16:19], s79 offen offset:1024 lds
    v_max_f32 v144, 0, v144
    v_max_f32 v145, 0, v145
    v_mfma_f32_32x32x16_bf16 v[156:171], v[180:183], v[36:39], v[156:171]
    ds_read_b64_tr_b16 v[180:181], v216 offset:55296
    ds_read_b64_tr_b16 v[182:183], v216 offset:55808
    s_add_u32 m0, s71, 81920
    s_add_u32 s79, s75, 384
    v_cvt_pk_bf16_f32 v202, v144, v145
    s_waitcnt lgkmcnt(6)
    v_mfma_f32_32x32x16_bf16 v[156:171], v[184:187], v[40:43], v[156:171]
    s_waitcnt vmcnt(8)
    s_barrier
    ds_read_b64_tr_b16 v[184:185], v216 offset:57344
    buffer_load_dwordx4 v244, s[16:19], s79 offen lds
    v_mfma_f32_32x32x16_bf16 v[156:171], v[188:191], v[44:47], v[156:171]
    ds_read_b64_tr_b16 v[186:187], v216 offset:57856
    ds_read_b64_tr_b16 v[188:189], v216 offset:59392
    ds_read_b64_tr_b16 v[190:191], v216 offset:59904
    v_max_f32 v146, 0, v146
    v_max_f32 v147, 0, v147
    s_waitcnt lgkmcnt(6)
    v_mfma_f32_32x32x16_bf16 v[156:171], v[172:175], v[48:51], v[156:171]
    ds_read_b64_tr_b16 v[172:173], v216 offset:61440
    ds_read_b64_tr_b16 v[174:175], v216 offset:61952
    buffer_load_dwordx4 v245, s[16:19], s79 offen offset:1024 lds
    v_cvt_pk_bf16_f32 v203, v146, v147
    v_max_f32 v148, 0, v148
    v_mfma_f32_32x32x16_bf16 v[156:171], v[176:179], v[52:55], v[156:171]
    ds_read_b64_tr_b16 v[176:177], v216 offset:63488
    ds_read_b64_tr_b16 v[178:179], v216 offset:64000
    s_add_u32 m0, s71, 90112
    s_add_u32 s79, s76, 384
    v_max_f32 v149, 0, v149
    s_waitcnt lgkmcnt(6)
    v_mfma_f32_32x32x16_bf16 v[156:171], v[180:183], v[56:59], v[156:171]
    ds_read_b64_tr_b16 v[180:181], v217 offset:0
    ds_read_b64_tr_b16 v[182:183], v217 offset:512
    buffer_load_dwordx4 v244, s[16:19], s79 offen lds
    v_cvt_pk_bf16_f32 v204, v148, v149
    v_max_f32 v150, 0, v150
    v_mfma_f32_32x32x16_bf16 v[156:171], v[184:187], v[60:63], v[156:171]
    ds_read_b64_tr_b16 v[184:185], v217 offset:2048
    ds_read_b64_tr_b16 v[186:187], v217 offset:2560
    v_max_f32 v151, 0, v151
    v_cvt_pk_bf16_f32 v205, v150, v151
    v_max_f32 v152, 0, v152
    s_waitcnt lgkmcnt(6)
    v_mfma_f32_32x32x16_bf16 v[156:171], v[188:191], v[64:67], v[156:171]
    ds_read_b64_tr_b16 v[188:189], v217 offset:4096
    ds_read_b64_tr_b16 v[190:191], v217 offset:4608
    buffer_load_dwordx4 v245, s[16:19], s79 offen offset:1024 lds
    v_max_f32 v153, 0, v153
    v_cvt_pk_bf16_f32 v206, v152, v153
    v_mfma_f32_32x32x16_bf16 v[156:171], v[172:175], v[68:71], v[156:171]
    ds_read_b64_tr_b16 v[172:173], v217 offset:6144
    ds_read_b64_tr_b16 v[174:175], v217 offset:6656
    s_add_u32 m0, s71, 98304
    s_add_u32 s79, s77, 384
    v_max_f32 v154, 0, v154
    s_waitcnt lgkmcnt(6)
    v_mfma_f32_32x32x16_bf16 v[156:171], v[176:179], v[72:75], v[156:171]
    ds_read_b64_tr_b16 v[176:177], v217 offset:8192
    ds_read_b64_tr_b16 v[178:179], v217 offset:8704
    buffer_load_dwordx4 v244, s[16:19], s79 offen lds
    v_max_f32 v155, 0, v155
    v_cvt_pk_bf16_f32 v207, v154, v155
    v_mfma_f32_32x32x16_bf16 v[156:171], v[180:183], v[76:79], v[156:171]
    ds_read_b64_tr_b16 v[180:181], v217 offset:10240
    ds_read_b64_tr_b16 v[182:183], v217 offset:10752
    s_waitcnt lgkmcnt(6)
    v_mfma_f32_32x32x16_bf16 v[156:171], v[184:187], v[80:83], v[156:171]
    ds_read_b64_tr_b16 v[184:185], v217 offset:12288
    buffer_load_dwordx4 v245, s[16:19], s79 offen offset:1024 lds
    v_mfma_f32_32x32x16_bf16 v[156:171], v[188:191], v[84:87], v[156:171]
    ds_read_b64_tr_b16 v[186:187], v217 offset:12800
    ds_read_b64_tr_b16 v[188:189], v217 offset:14336
    ds_read_b64_tr_b16 v[190:191], v217 offset:14848
    s_add_u32 m0, s71, 106496
    s_add_u32 s79, s78, 384
    s_waitcnt lgkmcnt(6)
    v_mfma_f32_32x32x16_bf16 v[156:171], v[172:175], v[88:91], v[156:171]
    s_waitcnt vmcnt(8)
    s_barrier
    ds_read_b64_tr_b16 v[172:173], v217 offset:16384
    buffer_load_dwordx4 v244, s[16:19], s79 offen lds
    v_mfma_f32_32x32x16_bf16 v[156:171], v[176:179], v[92:95], v[156:171]
    ds_read_b64_tr_b16 v[174:175], v217 offset:16896
    ds_read_b64_tr_b16 v[176:177], v217 offset:18432
    ds_read_b64_tr_b16 v[178:179], v217 offset:18944
    s_waitcnt lgkmcnt(6)
    v_mfma_f32_32x32x16_bf16 v[156:171], v[180:183], v[96:99], v[156:171]
    ds_read_b64_tr_b16 v[180:181], v217 offset:20480
    buffer_load_dwordx4 v245, s[16:19], s79 offen offset:1024 lds
    v_mfma_f32_32x32x16_bf16 v[156:171], v[184:187], v[100:103], v[156:171]
    ds_read_b64_tr_b16 v[182:183], v217 offset:20992
    ds_read_b64_tr_b16 v[184:185], v217 offset:22528
    ds_read_b64_tr_b16 v[186:187], v217 offset:23040
    s_add_u32 m0, s71, 114688
    s_waitcnt lgkmcnt(6)
    v_mfma_f32_32x32x16_bf16 v[156:171], v[188:191], v[104:107], v[156:171]
    ds_read_b64_tr_b16 v[188:189], v217 offset:24576
    buffer_load_dwordx4 v246, s[24:27], s64 offen lds
    v_mfma_f32_32x32x16_bf16 v[156:171], v[172:175], v[108:111], v[156:171]
    ds_read_b64_tr_b16 v[190:191], v217 offset:25088
    ds_read_b64_tr_b16 v[172:173], v217 offset:26624
    ds_read_b64_tr_b16 v[174:175], v217 offset:27136
    s_waitcnt lgkmcnt(6)
    v_mfma_f32_32x32x16_bf16 v[156:171], v[176:179], v[112:115], v[156:171]
    ds_read_b64_tr_b16 v[176:177], v217 offset:28672
    buffer_load_dwordx4 v247, s[24:27], s64 offen offset:1024 lds
    v_mfma_f32_32x32x16_bf16 v[156:171], v[180:183], v[116:119], v[156:171]
    ds_read_b64_tr_b16 v[178:179], v217 offset:29184
    ds_read_b64_tr_b16 v[180:181], v217 offset:30720
    ds_read_b64_tr_b16 v[182:183], v217 offset:31232
    s_add_u32 m0, s71, 122880
    s_add_u32 s79, s64, 57344
    s_waitcnt lgkmcnt(6)
    v_mfma_f32_32x32x16_bf16 v[156:171], v[184:187], v[120:123], v[156:171]
    ds_read_b64_tr_b16 v[184:185], v216 offset:0
    buffer_load_dwordx4 v246, s[24:27], s79 offen lds
    v_mfma_f32_32x32x16_bf16 v[124:139], v[188:191], v[12:15], 0
    ds_read_b64_tr_b16 v[186:187], v216 offset:512
    ds_read_b64_tr_b16 v[188:189], v216 offset:2048
    ds_read_b64_tr_b16 v[190:191], v216 offset:2560
    s_waitcnt lgkmcnt(6)
    v_mfma_f32_32x32x16_bf16 v[124:139], v[172:175], v[16:19], v[124:139]
    ds_read_b64_tr_b16 v[172:173], v216 offset:4096
    ds_read_b64_tr_b16 v[174:175], v216 offset:4608
    buffer_load_dwordx4 v247, s[24:27], s79 offen offset:1024 lds
    v_mfma_f32_32x32x16_bf16 v[124:139], v[176:179], v[20:23], v[124:139]
    ds_read_b64_tr_b16 v[176:177], v216 offset:6144
    ds_read_b64_tr_b16 v[178:179], v216 offset:6656
    s_add_u32 m0, s71, 131072
    s_add_u32 s79, s64, 114688
    v_max_f32 v156, 0, v156
    s_waitcnt lgkmcnt(6)
    v_mfma_f32_32x32x16_bf16 v[124:139], v[180:183], v[24:27], v[124:139]
    s_waitcnt vmcnt(8)
    s_barrier
    ds_read_b64_tr_b16 v[180:181], v216 offset:8192
    buffer_load_dwordx4 v246, s[24:27], s79 offen lds
    v_max_f32 v157, 0, v157
    v_cvt_pk_bf16_f32 v208, v156, v157
    v_mfma_f32_32x32x16_bf16 v[124:139], v[184:187], v[28:31], v[124:139]
    ds_read_b64_tr_b16 v[182:183], v216 offset:8704
    ds_read_b64_tr_b16 v[184:185], v216 offset:10240
    ds_read_b64_tr_b16 v[186:187], v216 offset:10752
    v_max_f32 v158, 0, v158
    v_max_f32 v159, 0, v159
    s_waitcnt lgkmcnt(6)
    v_mfma_f32_32x32x16_bf16 v[124:139], v[188:191], v[32:35], v[124:139]
    ds_read_b64_tr_b16 v[188:189], v216 offset:12288
    ds_read_b64_tr_b16 v[190:191], v216 offset:12800
    buffer_load_dwordx4 v247, s[24:27], s79 offen offset:1024 lds
    v_cvt_pk_bf16_f32 v209, v158, v159
    v_max_f32 v160, 0, v160
    v_mfma_f32_32x32x16_bf16 v[124:139], v[172:175], v[36:39], v[124:139]
    ds_read_b64_tr_b16 v[172:173], v216 offset:14336
    ds_read_b64_tr_b16 v[174:175], v216 offset:14848
    s_add_u32 m0, s71, 139264
    v_max_f32 v161, 0, v161
    v_cvt_pk_bf16_f32 v210, v160, v161
    s_waitcnt lgkmcnt(6)
    v_mfma_f32_32x32x16_bf16 v[124:139], v[176:179], v[40:43], v[124:139]
    ds_read_b64_tr_b16 v[176:177], v216 offset:16384
    ds_read_b64_tr_b16 v[178:179], v216 offset:16896
    buffer_load_dwordx4 v246, s[24:27], s65 offen lds
    v_max_f32 v162, 0, v162
    v_max_f32 v163, 0, v163
    v_mfma_f32_32x32x16_bf16 v[124:139], v[180:183], v[44:47], v[124:139]
    ds_read_b64_tr_b16 v[180:181], v216 offset:18432
    ds_read_b64_tr_b16 v[182:183], v216 offset:18944
    v_cvt_pk_bf16_f32 v211, v162, v163
    v_max_f32 v164, 0, v164
    v_max_f32 v165, 0, v165
    s_waitcnt lgkmcnt(6)
    v_mfma_f32_32x32x16_bf16 v[124:139], v[184:187], v[48:51], v[124:139]
    ds_read_b64_tr_b16 v[184:185], v216 offset:20480
    ds_read_b64_tr_b16 v[186:187], v216 offset:20992
    v_cvt_pk_bf16_f32 v212, v164, v165
    v_max_f32 v166, 0, v166
    v_max_f32 v167, 0, v167
    v_mfma_f32_32x32x16_bf16 v[124:139], v[188:191], v[52:55], v[124:139]
    ds_read_b64_tr_b16 v[188:189], v216 offset:22528
    ds_read_b64_tr_b16 v[190:191], v216 offset:23040
    v_cvt_pk_bf16_f32 v213, v166, v167
    v_max_f32 v168, 0, v168
    v_max_f32 v169, 0, v169
    s_waitcnt lgkmcnt(6)
    v_mfma_f32_32x32x16_bf16 v[124:139], v[172:175], v[56:59], v[124:139]
    ds_read_b64_tr_b16 v[172:173], v216 offset:24576
    ds_read_b64_tr_b16 v[174:175], v216 offset:25088
    v_cvt_pk_bf16_f32 v214, v168, v169
    v_max_f32 v170, 0, v170
    v_max_f32 v171, 0, v171
    v_mfma_f32_32x32x16_bf16 v[124:139], v[176:179], v[60:63], v[124:139]
    ds_read_b64_tr_b16 v[176:177], v216 offset:26624
    ds_read_b64_tr_b16 v[178:179], v216 offset:27136
    v_cvt_pk_bf16_f32 v215, v170, v171
    s_waitcnt lgkmcnt(6)
    v_mfma_f32_32x32x16_bf16 v[124:139], v[180:183], v[64:67], v[124:139]
    ds_read_b64_tr_b16 v[180:181], v216 offset:28672
    ds_read_b64_tr_b16 v[182:183], v216 offset:29184
    v_mfma_f32_32x32x16_bf16 v[124:139], v[184:187], v[68:71], v[124:139]
    ds_read_b64_tr_b16 v[184:185], v216 offset:30720
    ds_read_b64_tr_b16 v[186:187], v216 offset:31232
    s_waitcnt lgkmcnt(6)
    v_mfma_f32_32x32x16_bf16 v[124:139], v[188:191], v[72:75], v[124:139]
    s_waitcnt vmcnt(7)
    s_barrier
    ds_write_b128 v230, v[192:195] offset:0
    ds_write_b128 v230, v[196:199] offset:1024
    ds_write_b128 v230, v[200:203] offset:4096
    ds_write_b128 v230, v[204:207] offset:5120
    ds_write_b128 v230, v[208:211] offset:8192
    ds_write_b128 v230, v[212:215] offset:9216
    ds_read_b64_tr_b16 v[188:189], v216 offset:32768
    buffer_load_dwordx4 v247, s[24:27], s65 offen offset:1024 lds
    v_mfma_f32_32x32x16_bf16 v[124:139], v[172:175], v[76:79], v[124:139]
    ds_read_b64_tr_b16 v[190:191], v216 offset:33280
    ds_read_b64_tr_b16 v[172:173], v216 offset:34816
    s_waitcnt lgkmcnt(14)
    ds_read_b64_tr_b16 v[174:175], v216 offset:35328
    s_add_u32 m0, s71, 147456
    s_add_u32 s79, s65, 57344
    buffer_load_dwordx4 v246, s[24:27], s79 offen lds
    s_waitcnt lgkmcnt(12)
    v_mfma_f32_32x32x16_bf16 v[124:139], v[176:179], v[80:83], v[124:139]
    ds_read_b64_tr_b16 v[176:177], v216 offset:36864
    buffer_load_dwordx4 v247, s[24:27], s79 offen offset:1024 lds
    v_mfma_f32_32x32x16_bf16 v[124:139], v[180:183], v[84:87], v[124:139]
    ds_read_b64_tr_b16 v[178:179], v216 offset:37376
    ds_read_b64_tr_b16 v[180:181], v216 offset:38912
    s_waitcnt lgkmcnt(14)
    ds_read_b64_tr_b16 v[182:183], v216 offset:39424
    s_add_u32 m0, s71, 155648
    s_mul_i32 s79, s64, 448
    buffer_load_dwordx4 v248, s[28:31], s79 offen lds
    s_waitcnt lgkmcnt(6)
    v_mfma_f32_32x32x16_bf16 v[124:139], v[184:187], v[88:91], v[124:139]
    ds_read_b64_tr_b16 v[184:185], v216 offset:40960
    buffer_load_dwordx4 v249, s[28:31], s79 offen offset:1024 lds
    v_mfma_f32_32x32x16_bf16 v[124:139], v[188:191], v[92:95], v[124:139]
    ds_read_b64_tr_b16 v[186:187], v216 offset:41472
    ds_read_b64_tr_b16 v[188:189], v216 offset:43008
    ds_read_b64_tr_b16 v[190:191], v216 offset:43520
    s_add_u32 m0, s71, 65536
    s_mul_i32 s79, s64, 448
    buffer_load_dwordx4 v248, s[32:35], s79 offen lds
    s_waitcnt lgkmcnt(6)
    v_mfma_f32_32x32x16_bf16 v[124:139], v[172:175], v[96:99], v[124:139]
    ds_read_b64_tr_b16 v[172:173], v216 offset:45056
    buffer_load_dwordx4 v249, s[32:35], s79 offen offset:1024 lds
    v_mfma_f32_32x32x16_bf16 v[124:139], v[176:179], v[100:103], v[124:139]
    ds_read_b64_tr_b16 v[174:175], v216 offset:45568
    ds_read_b64_tr_b16 v[176:177], v216 offset:47104
    ds_read_b64_tr_b16 v[178:179], v216 offset:47616
    s_add_u32 m0, s71, 73728
    s_add_u32 s79, s64, 172032
    s_waitcnt lgkmcnt(6)
    v_mfma_f32_32x32x16_bf16 v[124:139], v[180:183], v[104:107], v[124:139]
    s_waitcnt vmcnt(6)
    s_barrier
    ds_read_b128 v[12:15], v231 offset:0
    ds_read_b64_tr_b16 v[180:181], v216 offset:49152
    ds_read_b64_tr_b16 v[182:183], v216 offset:49664
    buffer_load_dwordx4 v246, s[24:27], s79 offen lds
    v_mfma_f32_32x32x16_bf16 v[124:139], v[184:187], v[108:111], v[124:139]
    ds_read_b128 v[16:19], v231 offset:1024
    ds_read_b64_tr_b16 v[184:185], v216 offset:51200
    ds_read_b64_tr_b16 v[186:187], v216 offset:51712
    s_waitcnt lgkmcnt(8)
    v_mfma_f32_32x32x16_bf16 v[124:139], v[188:191], v[112:115], v[124:139]
    ds_read_b128 v[20:23], v231 offset:2048
    ds_read_b64_tr_b16 v[188:189], v216 offset:53248
    ds_read_b64_tr_b16 v[190:191], v216 offset:53760
    buffer_load_dwordx4 v247, s[24:27], s79 offen offset:1024 lds
    v_mfma_f32_32x32x16_bf16 v[124:139], v[172:175], v[116:119], v[124:139]
    ds_read_b128 v[24:27], v231 offset:3072
    ds_read_b64_tr_b16 v[172:173], v216 offset:55296
    ds_read_b64_tr_b16 v[174:175], v216 offset:55808
    s_add_u32 m0, s71, 81920
    s_add_u32 s79, s65, 114688
    s_waitcnt lgkmcnt(9)
    v_mfma_f32_32x32x16_bf16 v[124:139], v[176:179], v[120:123], v[124:139]
    ds_read_b128 v[28:31], v231 offset:4096
    ds_read_b64_tr_b16 v[176:177], v216 offset:57344
    ds_read_b64_tr_b16 v[178:179], v216 offset:57856
    buffer_load_dwordx4 v246, s[24:27], s79 offen lds
    v_mfma_f32_32x32x16_bf16 v[140:155], v[180:183], v[12:15], 0
    ds_read_b128 v[32:35], v231 offset:5120
    ds_read_b64_tr_b16 v[180:181], v216 offset:59392
    ds_read_b64_tr_b16 v[182:183], v216 offset:59904
    s_waitcnt lgkmcnt(9)
    v_mfma_f32_32x32x16_bf16 v[140:155], v[184:187], v[16:19], v[140:155]
    ds_read_b128 v[36:39], v231 offset:6144
    ds_read_b64_tr_b16 v[184:185], v216 offset:61440
    ds_read_b64_tr_b16 v[186:187], v216 offset:61952
    buffer_load_dwordx4 v247, s[24:27], s79 offen offset:1024 lds
    v_mfma_f32_32x32x16_bf16 v[140:155], v[188:191], v[20:23], v[140:155]
    ds_read_b128 v[40:43], v231 offset:7168
    ds_read_b64_tr_b16 v[188:189], v216 offset:63488
    ds_read_b64_tr_b16 v[190:191], v216 offset:64000
    s_add_u32 m0, s71, 90112
    s_mul_i32 s79, s65, 448
    v_max_f32 v124, 0, v124
    v_max_f32 v125, 0, v125
    v_cvt_pk_bf16_f32 v192, v124, v125
    v_max_f32 v126, 0, v126
    s_waitcnt lgkmcnt(9)
    v_mfma_f32_32x32x16_bf16 v[140:155], v[172:175], v[24:27], v[140:155]
    ds_read_b128 v[44:47], v231 offset:8192
    ds_read_b64_tr_b16 v[172:173], v217 offset:0
    ds_read_b64_tr_b16 v[174:175], v217 offset:512
    v_max_f32 v127, 0, v127
    v_cvt_pk_bf16_f32 v193, v126, v127
    v_max_f32 v128, 0, v128
    v_max_f32 v129, 0, v129
    v_mfma_f32_32x32x16_bf16 v[140:155], v[176:179], v[28:31], v[140:155]
    ds_read_b128 v[48:51], v231 offset:9216
    ds_read_b64_tr_b16 v[176:177], v217 offset:2048
    ds_read_b64_tr_b16 v[178:179], v217 offset:2560
    v_cvt_pk_bf16_f32 v194, v128, v129
    v_max_f32 v130, 0, v130
    v_max_f32 v131, 0, v131
    v_cvt_pk_bf16_f32 v195, v130, v131
    s_waitcnt lgkmcnt(9)
    v_mfma_f32_32x32x16_bf16 v[140:155], v[180:183], v[32:35], v[140:155]
    ds_read_b128 v[52:55], v231 offset:10240
    ds_read_b64_tr_b16 v[180:181], v217 offset:4096
    ds_read_b64_tr_b16 v[182:183], v217 offset:4608
    v_max_f32 v132, 0, v132
    v_max_f32 v133, 0, v133
    v_cvt_pk_bf16_f32 v196, v132, v133
    v_mfma_f32_32x32x16_bf16 v[140:155], v[184:187], v[36:39], v[140:155]
    ds_read_b128 v[56:59], v231 offset:11264
    ds_read_b64_tr_b16 v[184:185], v217 offset:6144
    ds_read_b64_tr_b16 v[186:187], v217 offset:6656
    v_max_f32 v134, 0, v134
    v_max_f32 v135, 0, v135
    v_cvt_pk_bf16_f32 v197, v134, v135
    s_waitcnt lgkmcnt(9)
    v_mfma_f32_32x32x16_bf16 v[140:155], v[188:191], v[40:43], v[140:155]
    ds_read_b64_tr_b16 v[188:189], v217 offset:8192
    ds_read_b64_tr_b16 v[190:191], v217 offset:8704
    v_max_f32 v136, 0, v136
    v_max_f32 v137, 0, v137
    v_cvt_pk_bf16_f32 v198, v136, v137
    v_mfma_f32_32x32x16_bf16 v[140:155], v[172:175], v[44:47], v[140:155]
    ds_read_b64_tr_b16 v[172:173], v217 offset:10240
    ds_read_b64_tr_b16 v[174:175], v217 offset:10752
    v_max_f32 v138, 0, v138
    v_max_f32 v139, 0, v139
    v_cvt_pk_bf16_f32 v199, v138, v139
    s_waitcnt lgkmcnt(7)
    v_mfma_f32_32x32x16_bf16 v[140:155], v[176:179], v[48:51], v[140:155]
    s_waitcnt vmcnt(8)
    s_barrier
    ds_write_b128 v230, v[192:195] offset:12288
    ds_write_b128 v230, v[196:199] offset:13312
    ds_read_b64_tr_b16 v[176:177], v217 offset:12288
    ds_read_b64_tr_b16 v[178:179], v217 offset:12800
    v_mfma_f32_32x32x16_bf16 v[140:155], v[180:183], v[52:55], v[140:155]
    ds_read_b64_tr_b16 v[180:181], v217 offset:14336
    ds_read_b64_tr_b16 v[182:183], v217 offset:14848
    s_waitcnt lgkmcnt(8)
    v_mfma_f32_32x32x16_bf16 v[140:155], v[184:187], v[56:59], v[140:155]
    ds_read_b64_tr_b16 v[184:185], v217 offset:16384
    ds_read_b64_tr_b16 v[186:187], v217 offset:16896
    v_mfma_f32_32x32x16_bf16 v[156:171], v[188:191], v[12:15], 0
    ds_read_b64_tr_b16 v[188:189], v217 offset:18432
    buffer_load_dwordx4 v248, s[28:31], s79 offen lds
    s_waitcnt lgkmcnt(5)
    v_mfma_f32_32x32x16_bf16 v[156:171], v[172:175], v[16:19], v[156:171]
    ds_read_b64_tr_b16 v[190:191], v217 offset:18944
    ds_read_b64_tr_b16 v[172:173], v217 offset:20480
    ds_read_b64_tr_b16 v[174:175], v217 offset:20992
    buffer_load_dwordx4 v249, s[28:31], s79 offen offset:1024 lds
    v_mfma_f32_32x32x16_bf16 v[156:171], v[176:179], v[20:23], v[156:171]
    ds_read_b64_tr_b16 v[176:177], v217 offset:22528
    ds_read_b64_tr_b16 v[178:179], v217 offset:23040
    s_add_u32 m0, s71, 98304
    s_mul_i32 s79, s65, 448
    buffer_load_dwordx4 v248, s[32:35], s79 offen lds
    s_waitcnt lgkmcnt(6)
    v_mfma_f32_32x32x16_bf16 v[156:171], v[180:183], v[24:27], v[156:171]
    s_waitcnt vmcnt(3)
    s_barrier
    ds_read_b64_tr_b16 v[60:61], v232 offset:32768
    ds_read_b64_tr_b16 v[62:63], v233 offset:33280
    ds_read_b128 v[180:183], v222 offset:24576
    buffer_load_dwordx4 v249, s[32:35], s79 offen offset:1024 lds
    v_mfma_f32_32x32x16_bf16 v[156:171], v[184:187], v[28:31], v[156:171]
    ds_read_b64_tr_b16 v[64:65], v232 offset:34816
    ds_read_b64_tr_b16 v[66:67], v233 offset:35328
    ds_read_b128 v[184:187], v223 offset:24576
    s_add_u32 m0, s71, 106496
    s_add_u32 s79, s65, 172032
    buffer_load_dwordx4 v246, s[24:27], s79 offen lds
    s_waitcnt lgkmcnt(8)
    v_mfma_f32_32x32x16_bf16 v[156:171], v[188:191], v[32:35], v[156:171]
    ds_read_b64_tr_b16 v[68:69], v232 offset:36864
    ds_read_b64_tr_b16 v[70:71], v233 offset:37376
    ds_read_b128 v[188:191], v224 offset:24576
    buffer_load_dwordx4 v247, s[24:27], s79 offen offset:1024 lds
    v_mov_b32 v3, 0
    v_mfma_f32_32x32x16_bf16 v[156:171], v[172:175], v[36:39], v[156:171]
    ds_read_b64_tr_b16 v[72:73], v232 offset:38912
    ds_read_b64_tr_b16 v[74:75], v233 offset:39424
    ds_read_b128 v[172:175], v225 offset:24576
    s_add_u32 m0, s71, 114688
    s_nop 0
    buffer_load_dwordx4 v246, s[24:27], s66 offen lds
    s_waitcnt lgkmcnt(9)
    v_mfma_f32_32x32x16_bf16 v[156:171], v[176:179], v[40:43], v[156:171]
    ds_read_b64_tr_b16 v[76:77], v232 offset:40960
    ds_read_b64_tr_b16 v[78:79], v233 offset:41472
    ds_read_b128 v[176:179], v218 offset:0
    buffer_load_dwordx4 v247, s[24:27], s66 offen offset:1024 lds
    ds_read_b32 v4, v3 offset:57856
    v_mfma_f32_32x32x16_bf16 v[140:155], v[180:183], v[60:63], v[140:155]
    ds_read_b64_tr_b16 v[80:81], v232 offset:43008
    ds_read_b64_tr_b16 v[82:83], v233 offset:43520
    s_waitcnt lgkmcnt(14)
    ds_read_b128 v[180:183], v219 offset:0
    s_add_u32 m0, s71, 122880
    s_add_u32 s79, s66, 57344
    buffer_load_dwordx4 v246, s[24:27], s79 offen lds
    s_waitcnt lgkmcnt(10)
    v_mfma_f32_32x32x16_bf16 v[140:155], v[184:187], v[64:67], v[140:155]
    ds_read_b64_tr_b16 v[84:85], v232 offset:45056
    ds_read_b64_tr_b16 v[86:87], v233 offset:45568
    ds_read_b128 v[184:187], v220 offset:0
    buffer_load_dwordx4 v247, s[24:27], s79 offen offset:1024 lds
    v_mfma_f32_32x32x16_bf16 v[140:155], v[188:191], v[68:71], v[140:155]
    ds_read_b64_tr_b16 v[88:89], v232 offset:47104
    ds_read_b64_tr_b16 v[90:91], v233 offset:47616
    s_waitcnt lgkmcnt(14)
    ds_read_b128 v[188:191], v221 offset:0
    s_add_u32 m0, s71, 131072
    s_add_u32 s79, s66, 114688
    s_waitcnt lgkmcnt(10)
    v_mfma_f32_32x32x16_bf16 v[140:155], v[172:175], v[72:75], v[140:155]
    ds_read_b128 v[92:95], v231 offset:12288
    ds_read_b64_tr_b16 v[172:173], v216 offset:8192
    ds_read_b64_tr_b16 v[174:175], v216 offset:8704
    buffer_load_dwordx4 v246, s[24:27], s79 offen lds
    v_mfma_f32_32x32x16_bf16 v[140:155], v[176:179], v[76:79], v[140:155]
    ds_read_b128 v[96:99], v231 offset:13312
    ds_read_b64_tr_b16 v[176:177], v216 offset:10240
    s_waitcnt lgkmcnt(14)
    ds_read_b64_tr_b16 v[178:179], v216 offset:10752
    s_waitcnt lgkmcnt(9)
    v_mfma_f32_32x32x16_bf16 v[140:155], v[180:183], v[80:83], v[140:155]
    ds_read_b128 v[100:103], v231 offset:14336
    ds_read_b64_tr_b16 v[180:181], v216 offset:12288
    ds_read_b64_tr_b16 v[182:183], v216 offset:12800
    buffer_load_dwordx4 v247, s[24:27], s79 offen offset:1024 lds
    v_mfma_f32_32x32x16_bf16 v[140:155], v[184:187], v[84:87], v[140:155]
    ds_read_b128 v[104:107], v231 offset:15360
    ds_read_b64_tr_b16 v[184:185], v216 offset:14336
    ds_read_b64_tr_b16 v[186:187], v216 offset:14848
    s_add_u32 m0, s71, 139264
    s_mul_i32 s79, s66, 448
    s_waitcnt lgkmcnt(9)
    v_mfma_f32_32x32x16_bf16 v[140:155], v[188:191], v[88:91], v[140:155]
    ds_read_b64_tr_b16 v[188:189], v216 offset:16384
    buffer_load_dwordx4 v248, s[28:31], s79 offen lds
    v_mfma_f32_32x32x16_bf16 v[140:155], v[172:175], v[92:95], v[140:155]
    ds_read_b64_tr_b16 v[190:191], v216 offset:16896
    ds_read_b64_tr_b16 v[172:173], v216 offset:18432
    ds_read_b64_tr_b16 v[174:175], v216 offset:18944
    s_waitcnt lgkmcnt(7)
    v_mfma_f32_32x32x16_bf16 v[140:155], v[176:179], v[96:99], v[140:155]
    ds_read_b64_tr_b16 v[176:177], v216 offset:20480
    ds_read_b64_tr_b16 v[178:179], v216 offset:20992
    buffer_load_dwordx4 v249, s[28:31], s79 offen offset:1024 lds
    v_add_u32 v239, v239, v4
    v_xor_b32 v4, 32, v238
    v_mfma_f32_32x32x16_bf16 v[140:155], v[180:183], v[100:103], v[140:155]
    ds_read_b64_tr_b16 v[180:181], v216 offset:22528
    ds_read_b64_tr_b16 v[182:183], v216 offset:23040
    s_add_u32 m0, s71, 147456
    s_mul_i32 s79, s66, 448
    v_xor_b32 v5, 64, v238
    v_xor_b32 v6, 96, v238
    s_waitcnt lgkmcnt(6)
    v_mfma_f32_32x32x16_bf16 v[140:155], v[184:187], v[104:107], v[140:155]
    s_waitcnt vmcnt(6)
    s_barrier
    ds_read_b128 v[184:187], v218 offset:24576
    buffer_load_dwordx4 v248, s[32:35], s79 offen lds
    v_mfma_f32_32x32x16_bf16 v[156:171], v[188:191], v[44:47], v[156:171]
    ds_read_b128 v[188:191], v219 offset:24576
    s_waitcnt lgkmcnt(4)
    v_mfma_f32_32x32x16_bf16 v[156:171], v[172:175], v[48:51], v[156:171]
    ds_read_b128 v[172:175], v220 offset:24576
    buffer_load_dwordx4 v249, s[32:35], s79 offen offset:1024 lds
    s_mul_i32 s80, s64, 768
    s_add_u32 s80, s80, 0
    v_perm_b32 v192, v141, v140, s85
    v_mfma_f32_32x32x16_bf16 v[156:171], v[176:179], v[52:55], v[156:171]
    ds_read_b128 v[176:179], v221 offset:24576
    s_add_u32 m0, s71, 155648
    s_add_u32 s79, s66, 172032
    v_perm_b32 v193, v143, v142, s85
    v_perm_b32 v194, v145, v144, s85
    v_perm_b32 v195, v147, v146, s85
    s_waitcnt lgkmcnt(3)
    v_mfma_f32_32x32x16_bf16 v[156:171], v[180:183], v[56:59], v[156:171]
    ds_read_b128 v[180:183], v218 offset:32768
    buffer_load_dwordx4 v246, s[24:27], s79 offen lds
    v_bitop3_b32 v192, v192, v234, s3 bitop3:0xd8
    v_bitop3_b32 v193, v193, v235, s3 bitop3:0xd8
    v_bitop3_b32 v194, v194, v236, s3 bitop3:0xd8
    v_mfma_f32_32x32x16_bf16 v[156:171], v[184:187], v[60:63], v[156:171]
    ds_read_b128 v[184:187], v219 offset:32768
    v_bitop3_b32 v195, v195, v237, s3 bitop3:0xd8
    v_perm_b32 v196, v149, v148, s85
    v_perm_b32 v197, v151, v150, s85
    s_waitcnt lgkmcnt(3)
    v_mfma_f32_32x32x16_bf16 v[156:171], v[188:191], v[64:67], v[156:171]
    ds_read_b128 v[188:191], v220 offset:32768
    buffer_load_dwordx4 v247, s[24:27], s79 offen offset:1024 lds
    v_perm_b32 v198, v153, v152, s85
    v_perm_b32 v199, v155, v154, s85
    v_bitop3_b32 v196, v196, v234, s3 bitop3:0xd8
    v_mfma_f32_32x32x16_bf16 v[156:171], v[172:175], v[68:71], v[156:171]
    ds_read_b128 v[172:175], v221 offset:32768
    s_add_u32 m0, s71, 65536
    v_bitop3_b32 v197, v197, v235, s3 bitop3:0xd8
    v_bitop3_b32 v198, v198, v236, s3 bitop3:0xd8
    v_bitop3_b32 v199, v199, v237, s3 bitop3:0xd8
    s_waitcnt lgkmcnt(3)
    v_mfma_f32_32x32x16_bf16 v[156:171], v[176:179], v[72:75], v[156:171]
L_pad1:
    s_cmp_eq_u32 s51, 1
    s_cbranch_scc1 L_pad5
    ds_read_b64_tr_b16 v[176:177], v216 offset:40960
    ds_read_b64_tr_b16 v[178:179], v216 offset:41472
    buffer_load_dwordx4 v246, s[24:27], s67 offen lds
    buffer_store_dwordx4 v[192:195], v239, s[36:39], s80 offen offset:0 sc1
    buffer_store_dwordx4 v[196:199], v239, s[36:39], s80 offen offset:1024 sc1
    v_mfma_f32_32x32x16_bf16 v[156:171], v[180:183], v[76:79], v[156:171]
    ds_read_b64_tr_b16 v[180:181], v216 offset:43008
    ds_read_b64_tr_b16 v[182:183], v216 offset:43520
    s_waitcnt lgkmcnt(5)
    v_mfma_f32_32x32x16_bf16 v[156:171], v[184:187], v[80:83], v[156:171]
    ds_read_b64_tr_b16 v[184:185], v216 offset:45056
    buffer_load_dwordx4 v247, s[24:27], s67 offen offset:1024 lds
    v_mfma_f32_32x32x16_bf16 v[156:171], v[188:191], v[84:87], v[156:171]
    ds_read_b64_tr_b16 v[186:187], v216 offset:45568
    ds_read_b64_tr_b16 v[188:189], v216 offset:47104
    ds_read_b64_tr_b16 v[190:191], v216 offset:47616
    s_add_u32 m0, s71, 73728
    s_add_u32 s79, s67, 57344
    s_waitcnt lgkmcnt(6)
    v_mfma_f32_32x32x16_bf16 v[156:171], v[172:175], v[88:91], v[156:171]
    ds_read_b64_tr_b16 v[172:173], v216 offset:49152
    buffer_load_dwordx4 v246, s[24:27], s79 offen lds
    v_mfma_f32_32x32x16_bf16 v[156:171], v[176:179], v[92:95], v[156:171]
    ds_read_b64_tr_b16 v[174:175], v216 offset:49664
    ds_read_b64_tr_b16 v[176:177], v216 offset:51200
    ds_read_b64_tr_b16 v[178:179], v216 offset:51712
    s_waitcnt lgkmcnt(6)
    v_mfma_f32_32x32x16_bf16 v[156:171], v[180:183], v[96:99], v[156:171]
    ds_read_b64_tr_b16 v[180:181], v216 offset:53248
    buffer_load_dwordx4 v247, s[24:27], s79 offen offset:1024 lds
    v_mfma_f32_32x32x16_bf16 v[156:171], v[184:187], v[100:103], v[156:171]
    ds_read_b64_tr_b16 v[182:183], v216 offset:53760
    ds_read_b64_tr_b16 v[184:185], v216 offset:55296
    ds_read_b64_tr_b16 v[186:187], v216 offset:55808
    s_add_u32 m0, s71, 81920
    s_add_u32 s79, s67, 114688
    s_waitcnt lgkmcnt(6)
    v_mfma_f32_32x32x16_bf16 v[156:171], v[188:191], v[104:107], v[156:171]
    s_waitcnt vmcnt(10)
    s_barrier
    ds_read_b64_tr_b16 v[188:189], v216 offset:57344
    buffer_load_dwordx4 v246, s[24:27], s79 offen lds
    v_mfma_f32_32x32x16_bf16 v[108:123], v[172:175], v[12:15], 0
    ds_read_b64_tr_b16 v[190:191], v216 offset:57856
    ds_read_b64_tr_b16 v[172:173], v216 offset:59392
    ds_read_b64_tr_b16 v[174:175], v216 offset:59904
    s_waitcnt lgkmcnt(6)
    v_mfma_f32_32x32x16_bf16 v[108:123], v[176:179], v[16:19], v[108:123]
    ds_read_b64_tr_b16 v[176:177], v216 offset:61440
    ds_read_b64_tr_b16 v[178:179], v216 offset:61952
    buffer_load_dwordx4 v247, s[24:27], s79 offen offset:1024 lds
    s_mul_i32 s80, s65, 768
    s_add_u32 s80, s80, 16384
    v_perm_b32 v200, v157, v156, s85
    v_mfma_f32_32x32x16_bf16 v[108:123], v[180:183], v[20:23], v[108:123]
    ds_read_b64_tr_b16 v[180:181], v216 offset:63488
    ds_read_b64_tr_b16 v[182:183], v216 offset:64000
    s_add_u32 m0, s71, 90112
    s_mul_i32 s79, s67, 448
    v_perm_b32 v201, v159, v158, s85
    v_perm_b32 v202, v161, v160, s85
    v_perm_b32 v203, v163, v162, s85
    s_waitcnt lgkmcnt(6)
    v_mfma_f32_32x32x16_bf16 v[108:123], v[184:187], v[24:27], v[108:123]
    ds_read_b64_tr_b16 v[184:185], v217 offset:0
    ds_read_b64_tr_b16 v[186:187], v217 offset:512
    buffer_load_dwordx4 v248, s[28:31], s79 offen lds
    v_bitop3_b32 v200, v200, v234, s3 bitop3:0xd8
    v_bitop3_b32 v201, v201, v235, s3 bitop3:0xd8
    v_bitop3_b32 v202, v202, v236, s3 bitop3:0xd8
    v_mfma_f32_32x32x16_bf16 v[108:123], v[188:191], v[28:31], v[108:123]
    ds_read_b64_tr_b16 v[188:189], v217 offset:2048
    ds_read_b64_tr_b16 v[190:191], v217 offset:2560
    v_bitop3_b32 v203, v203, v237, s3 bitop3:0xd8
    v_perm_b32 v204, v165, v164, s85
    v_perm_b32 v205, v167, v166, s85
    s_waitcnt lgkmcnt(6)
    v_mfma_f32_32x32x16_bf16 v[108:123], v[172:175], v[32:35], v[108:123]
    ds_read_b64_tr_b16 v[172:173], v217 offset:4096
    ds_read_b64_tr_b16 v[174:175], v217 offset:4608
    buffer_load_dwordx4 v249, s[28:31], s79 offen offset:1024 lds
    v_perm_b32 v206, v169, v168, s85
    v_perm_b32 v207, v171, v170, s85
    v_bitop3_b32 v204, v204, v234, s3 bitop3:0xd8
    v_mfma_f32_32x32x16_bf16 v[108:123], v[176:179], v[36:39], v[108:123]
    ds_read_b64_tr_b16 v[176:177], v217 offset:6144
    ds_read_b64_tr_b16 v[178:179], v217 offset:6656
    s_add_u32 m0, s71, 98304
    s_mul_i32 s79, s67, 448
    v_bitop3_b32 v205, v205, v235, s3 bitop3:0xd8
    v_bitop3_b32 v206, v206, v236, s3 bitop3:0xd8
    v_bitop3_b32 v207, v207, v237, s3 bitop3:0xd8
    s_waitcnt lgkmcnt(6)
    v_mfma_f32_32x32x16_bf16 v[108:123], v[180:183], v[40:43], v[108:123]
    ds_read_b128 v[180:183], v222 offset:8192
    buffer_load_dwordx4 v248, s[32:35], s79 offen lds
    buffer_store_dwordx4 v[200:203], v239, s[36:39], s80 offen offset:0 sc1
    buffer_store_dwordx4 v[204:207], v239, s[36:39], s80 offen offset:1024 sc1
    v_mfma_f32_32x32x16_bf16 v[108:123], v[184:187], v[44:47], v[108:123]
    ds_read_b128 v[184:187], v223 offset:8192
    s_waitcnt lgkmcnt(4)
    v_mfma_f32_32x32x16_bf16 v[108:123], v[188:191], v[48:51], v[108:123]
    ds_read_b128 v[188:191], v224 offset:8192
    buffer_load_dwordx4 v249, s[32:35], s79 offen offset:1024 lds
    v_mfma_f32_32x32x16_bf16 v[108:123], v[172:175], v[52:55], v[108:123]
    ds_read_b128 v[172:175], v225 offset:8192
    s_add_u32 m0, s71, 106496
    s_add_u32 s79, s67, 172032
    s_waitcnt lgkmcnt(3)
    v_mfma_f32_32x32x16_bf16 v[108:123], v[176:179], v[56:59], v[108:123]
    s_waitcnt vmcnt(8)
    s_barrier
    ds_read_b128 v[176:179], v222 offset:16384
    buffer_load_dwordx4 v246, s[24:27], s79 offen lds
    v_mfma_f32_32x32x16_bf16 v[108:123], v[180:183], v[60:63], v[108:123]
    ds_read_b128 v[180:183], v223 offset:16384
    s_waitcnt lgkmcnt(3)
    v_mfma_f32_32x32x16_bf16 v[108:123], v[184:187], v[64:67], v[108:123]
    ds_read_b128 v[184:187], v224 offset:16384
    buffer_load_dwordx4 v247, s[24:27], s79 offen offset:1024 lds
    v_mfma_f32_32x32x16_bf16 v[108:123], v[188:191], v[68:71], v[108:123]
    ds_read_b128 v[188:191], v225 offset:16384
    s_add_u32 m0, s71, 114688
    s_waitcnt lgkmcnt(3)
    v_mfma_f32_32x32x16_bf16 v[108:123], v[172:175], v[72:75], v[108:123]
    ds_read_b64_tr_b16 v[172:173], v217 offset:24576
    buffer_load_dwordx4 v246, s[24:27], s68 offen lds
    v_mfma_f32_32x32x16_bf16 v[108:123], v[176:179], v[76:79], v[108:123]
    ds_read_b64_tr_b16 v[174:175], v217 offset:25088
    ds_read_b64_tr_b16 v[176:177], v217 offset:26624
    ds_read_b64_tr_b16 v[178:179], v217 offset:27136
    s_waitcnt lgkmcnt(5)
    v_mfma_f32_32x32x16_bf16 v[108:123], v[180:183], v[80:83], v[108:123]
    ds_read_b64_tr_b16 v[180:181], v217 offset:28672
    buffer_load_dwordx4 v247, s[24:27], s68 offen offset:1024 lds
    v_mfma_f32_32x32x16_bf16 v[108:123], v[184:187], v[84:87], v[108:123]
    ds_read_b64_tr_b16 v[182:183], v217 offset:29184
    ds_read_b64_tr_b16 v[184:185], v217 offset:30720
    ds_read_b64_tr_b16 v[186:187], v217 offset:31232
    s_add_u32 m0, s71, 122880
    s_add_u32 s79, s68, 57344
    s_waitcnt lgkmcnt(6)
    v_mfma_f32_32x32x16_bf16 v[108:123], v[188:191], v[88:91], v[108:123]
    ds_read_b64_tr_b16 v[188:189], v216 offset:0
    buffer_load_dwordx4 v246, s[24:27], s79 offen lds
    v_mfma_f32_32x32x16_bf16 v[108:123], v[172:175], v[92:95], v[108:123]
    ds_read_b64_tr_b16 v[190:191], v216 offset:512
    ds_read_b64_tr_b16 v[172:173], v216 offset:2048
    ds_read_b64_tr_b16 v[174:175], v216 offset:2560
    s_waitcnt lgkmcnt(6)
    v_mfma_f32_32x32x16_bf16 v[108:123], v[176:179], v[96:99], v[108:123]
    ds_read_b64_tr_b16 v[176:177], v216 offset:4096
    buffer_load_dwordx4 v247, s[24:27], s79 offen offset:1024 lds
    v_mfma_f32_32x32x16_bf16 v[108:123], v[180:183], v[100:103], v[108:123]
    ds_read_b64_tr_b16 v[178:179], v216 offset:4608
    ds_read_b64_tr_b16 v[180:181], v216 offset:6144
    ds_read_b64_tr_b16 v[182:183], v216 offset:6656
    s_add_u32 m0, s71, 131072
    s_add_u32 s79, s68, 114688
    s_waitcnt lgkmcnt(6)
    v_mfma_f32_32x32x16_bf16 v[108:123], v[184:187], v[104:107], v[108:123]
    ds_read_b64_tr_b16 v[184:185], v216 offset:8192
    buffer_load_dwordx4 v246, s[24:27], s79 offen lds
    v_mfma_f32_32x32x16_bf16 v[124:139], v[188:191], v[12:15], 0
    ds_read_b64_tr_b16 v[186:187], v216 offset:8704
    ds_read_b64_tr_b16 v[188:189], v216 offset:10240
    ds_read_b64_tr_b16 v[190:191], v216 offset:10752
    s_waitcnt lgkmcnt(6)
    v_mfma_f32_32x32x16_bf16 v[124:139], v[172:175], v[16:19], v[124:139]
    ds_read_b64_tr_b16 v[172:173], v216 offset:12288
    ds_read_b64_tr_b16 v[174:175], v216 offset:12800
    buffer_load_dwordx4 v247, s[24:27], s79 offen offset:1024 lds
    s_mul_i32 s80, s66, 768
    s_add_u32 s80, s80, 32768
    v_perm_b32 v192, v109, v108, s85
    v_mfma_f32_32x32x16_bf16 v[124:139], v[176:179], v[20:23], v[124:139]
    ds_read_b64_tr_b16 v[176:177], v216 offset:14336
    ds_read_b64_tr_b16 v[178:179], v216 offset:14848
    s_add_u32 m0, s71, 139264
    s_mul_i32 s79, s68, 448
    v_perm_b32 v193, v111, v110, s85
    v_perm_b32 v194, v113, v112, s85
    v_perm_b32 v195, v115, v114, s85
    s_waitcnt lgkmcnt(6)
    v_mfma_f32_32x32x16_bf16 v[124:139], v[180:183], v[24:27], v[124:139]
    s_waitcnt vmcnt(6)
    s_barrier
    ds_read_b64_tr_b16 v[180:181], v216 offset:16384
    buffer_load_dwordx4 v248, s[28:31], s79 offen lds
    v_bitop3_b32 v192, v192, v234, s3 bitop3:0xd8
    v_bitop3_b32 v193, v193, v235, s3 bitop3:0xd8
    v_bitop3_b32 v194, v194, v236, s3 bitop3:0xd8
    v_mfma_f32_32x32x16_bf16 v[124:139], v[184:187], v[28:31], v[124:139]
    ds_read_b64_tr_b16 v[182:183], v216 offset:16896
    ds_read_b64_tr_b16 v[184:185], v216 offset:18432
    ds_read_b64_tr_b16 v[186:187], v216 offset:18944
    v_bitop3_b32 v195, v195, v237, s3 bitop3:0xd8
    v_perm_b32 v196, v117, v116, s85
    v_perm_b32 v197, v119, v118, s85
    s_waitcnt lgkmcnt(6)
    v_mfma_f32_32x32x16_bf16 v[124:139], v[188:191], v[32:35], v[124:139]
    ds_read_b64_tr_b16 v[188:189], v216 offset:20480
    ds_read_b64_tr_b16 v[190:191], v216 offset:20992
    buffer_load_dwordx4 v249, s[28:31], s79 offen offset:1024 lds
    v_perm_b32 v198, v121, v120, s85
    v_perm_b32 v199, v123, v122, s85
    v_bitop3_b32 v196, v196, v234, s3 bitop3:0xd8
    v_mfma_f32_32x32x16_bf16 v[124:139], v[172:175], v[36:39], v[124:139]
    ds_read_b64_tr_b16 v[172:173], v216 offset:22528
    ds_read_b64_tr_b16 v[174:175], v216 offset:23040
    s_add_u32 m0, s71, 147456
    s_mul_i32 s79, s68, 448
    v_bitop3_b32 v197, v197, v235, s3 bitop3:0xd8
    v_bitop3_b32 v198, v198, v236, s3 bitop3:0xd8
    v_bitop3_b32 v199, v199, v237, s3 bitop3:0xd8
    s_waitcnt lgkmcnt(6)
    v_mfma_f32_32x32x16_bf16 v[124:139], v[176:179], v[40:43], v[124:139]
    ds_read_b128 v[176:179], v218 offset:24576
    buffer_load_dwordx4 v248, s[32:35], s79 offen lds
    buffer_store_dwordx4 v[192:195], v239, s[36:39], s80 offen offset:0 sc1
    buffer_store_dwordx4 v[196:199], v239, s[36:39], s80 offen offset:1024 sc1
    v_mfma_f32_32x32x16_bf16 v[124:139], v[180:183], v[44:47], v[124:139]
    ds_read_b128 v[180:183], v219 offset:24576
    s_waitcnt lgkmcnt(4)
    v_mfma_f32_32x32x16_bf16 v[124:139], v[184:187], v[48:51], v[124:139]
    ds_read_b128 v[184:187], v220 offset:24576
    buffer_load_dwordx4 v249, s[32:35], s79 offen offset:1024 lds
    v_mfma_f32_32x32x16_bf16 v[124:139], v[188:191], v[52:55], v[124:139]
    ds_read_b128 v[188:191], v221 offset:24576
    s_add_u32 m0, s71, 155648
    s_add_u32 s79, s68, 172032
    s_waitcnt lgkmcnt(3)
    v_mfma_f32_32x32x16_bf16 v[124:139], v[172:175], v[56:59], v[124:139]
    ds_read_b128 v[172:175], v218 offset:32768
    buffer_load_dwordx4 v246, s[24:27], s79 offen lds
    v_mfma_f32_32x32x16_bf16 v[124:139], v[176:179], v[60:63], v[124:139]
    ds_read_b128 v[176:179], v219 offset:32768
    s_waitcnt lgkmcnt(3)
    v_mfma_f32_32x32x16_bf16 v[124:139], v[180:183], v[64:67], v[124:139]
    ds_read_b128 v[180:183], v220 offset:32768
    buffer_load_dwordx4 v247, s[24:27], s79 offen offset:1024 lds
    v_mfma_f32_32x32x16_bf16 v[124:139], v[184:187], v[68:71], v[124:139]
    ds_read_b128 v[184:187], v221 offset:32768
    s_add_u32 m0, s71, 65536
    s_waitcnt lgkmcnt(3)
    v_mfma_f32_32x32x16_bf16 v[124:139], v[188:191], v[72:75], v[124:139]
    ds_read_b64_tr_b16 v[188:189], v216 offset:40960
    buffer_load_dwordx4 v246, s[24:27], s69 offen lds
    v_mfma_f32_32x32x16_bf16 v[124:139], v[172:175], v[76:79], v[124:139]
    ds_read_b64_tr_b16 v[190:191], v216 offset:41472
    ds_read_b64_tr_b16 v[172:173], v216 offset:43008
    ds_read_b64_tr_b16 v[174:175], v216 offset:43520
    s_waitcnt lgkmcnt(5)
    v_mfma_f32_32x32x16_bf16 v[124:139], v[176:179], v[80:83], v[124:139]
    ds_read_b64_tr_b16 v[176:177], v216 offset:45056
    buffer_load_dwordx4 v247, s[24:27], s69 offen offset:1024 lds
    v_mfma_f32_32x32x16_bf16 v[124:139], v[180:183], v[84:87], v[124:139]
    ds_read_b64_tr_b16 v[178:179], v216 offset:45568
    ds_read_b64_tr_b16 v[180:181], v216 offset:47104
    ds_read_b64_tr_b16 v[182:183], v216 offset:47616
    s_add_u32 m0, s71, 73728
    s_add_u32 s79, s69, 57344
    s_waitcnt lgkmcnt(6)
    v_mfma_f32_32x32x16_bf16 v[124:139], v[184:187], v[88:91], v[124:139]
    s_waitcnt vmcnt(8)
    s_barrier
    ds_read_b64_tr_b16 v[184:185], v216 offset:49152
    buffer_load_dwordx4 v246, s[24:27], s79 offen lds
    v_mfma_f32_32x32x16_bf16 v[124:139], v[188:191], v[92:95], v[124:139]
    ds_read_b64_tr_b16 v[186:187], v216 offset:49664
    ds_read_b64_tr_b16 v[188:189], v216 offset:51200
    ds_read_b64_tr_b16 v[190:191], v216 offset:51712
    s_waitcnt lgkmcnt(6)
    v_mfma_f32_32x32x16_bf16 v[124:139], v[172:175], v[96:99], v[124:139]
    ds_read_b64_tr_b16 v[172:173], v216 offset:53248
    buffer_load_dwordx4 v247, s[24:27], s79 offen offset:1024 lds
    v_mfma_f32_32x32x16_bf16 v[124:139], v[176:179], v[100:103], v[124:139]
    ds_read_b64_tr_b16 v[174:175], v216 offset:53760
    ds_read_b64_tr_b16 v[176:177], v216 offset:55296
    ds_read_b64_tr_b16 v[178:179], v216 offset:55808
    s_add_u32 m0, s71, 81920
    s_add_u32 s79, s69, 114688
    s_waitcnt lgkmcnt(6)
    v_mfma_f32_32x32x16_bf16 v[124:139], v[180:183], v[104:107], v[124:139]
    ds_read_b64_tr_b16 v[180:181], v216 offset:57344
    buffer_load_dwordx4 v246, s[24:27], s79 offen lds
    v_mfma_f32_32x32x16_bf16 v[140:155], v[184:187], v[12:15], 0
    ds_read_b64_tr_b16 v[182:183], v216 offset:57856
    ds_read_b64_tr_b16 v[184:185], v216 offset:59392
    ds_read_b64_tr_b16 v[186:187], v216 offset:59904
    s_waitcnt lgkmcnt(6)
    v_mfma_f32_32x32x16_bf16 v[140:155], v[188:191], v[16:19], v[140:155]
    ds_read_b64_tr_b16 v[188:189], v216 offset:61440
    ds_read_b64_tr_b16 v[190:191], v216 offset:61952
    buffer_load_dwordx4 v247, s[24:27], s79 offen offset:1024 lds
    s_mul_i32 s80, s67, 768
    s_add_u32 s80, s80, 49152
    v_perm_b32 v200, v125, v124, s85
    v_mfma_f32_32x32x16_bf16 v[140:155], v[172:175], v[20:23], v[140:155]
    ds_read_b64_tr_b16 v[172:173], v216 offset:63488
    ds_read_b64_tr_b16 v[174:175], v216 offset:64000
    s_add_u32 m0, s71, 90112
    s_mul_i32 s79, s69, 448
    v_perm_b32 v201, v127, v126, s85
    v_perm_b32 v202, v129, v128, s85
    v_perm_b32 v203, v131, v130, s85
    s_waitcnt lgkmcnt(6)
    v_mfma_f32_32x32x16_bf16 v[140:155], v[176:179], v[24:27], v[140:155]
    ds_read_b64_tr_b16 v[176:177], v217 offset:0
    ds_read_b64_tr_b16 v[178:179], v217 offset:512
    buffer_load_dwordx4 v248, s[28:31], s79 offen lds
    v_bitop3_b32 v200, v200, v234, s3 bitop3:0xd8
    v_bitop3_b32 v201, v201, v235, s3 bitop3:0xd8
    v_bitop3_b32 v202, v202, v236, s3 bitop3:0xd8
    v_mfma_f32_32x32x16_bf16 v[140:155], v[180:183], v[28:31], v[140:155]
    ds_read_b64_tr_b16 v[180:181], v217 offset:2048
    ds_read_b64_tr_b16 v[182:183], v217 offset:2560
    v_bitop3_b32 v203, v203, v237, s3 bitop3:0xd8
    v_perm_b32 v204, v133, v132, s85
    v_perm_b32 v205, v135, v134, s85
    s_waitcnt lgkmcnt(6)
    v_mfma_f32_32x32x16_bf16 v[140:155], v[184:187], v[32:35], v[140:155]
    ds_read_b64_tr_b16 v[184:185], v217 offset:4096
    ds_read_b64_tr_b16 v[186:187], v217 offset:4608
    buffer_load_dwordx4 v249, s[28:31], s79 offen offset:1024 lds
    v_perm_b32 v206, v137, v136, s85
    v_perm_b32 v207, v139, v138, s85
    v_bitop3_b32 v204, v204, v234, s3 bitop3:0xd8
    v_mfma_f32_32x32x16_bf16 v[140:155], v[188:191], v[36:39], v[140:155]
    ds_read_b64_tr_b16 v[188:189], v217 offset:6144
    ds_read_b64_tr_b16 v[190:191], v217 offset:6656
    s_add_u32 m0, s71, 98304
    s_mul_i32 s79, s69, 448
    v_bitop3_b32 v205, v205, v235, s3 bitop3:0xd8
    v_bitop3_b32 v206, v206, v236, s3 bitop3:0xd8
    v_bitop3_b32 v207, v207, v237, s3 bitop3:0xd8
    s_waitcnt lgkmcnt(6)
    v_mfma_f32_32x32x16_bf16 v[140:155], v[172:175], v[40:43], v[140:155]
    ds_read_b128 v[172:175], v222 offset:8192
    buffer_load_dwordx4 v248, s[32:35], s79 offen lds
    buffer_store_dwordx4 v[200:203], v239, s[36:39], s80 offen offset:0 sc1
    buffer_store_dwordx4 v[204:207], v239, s[36:39], s80 offen offset:1024 sc1
    v_mfma_f32_32x32x16_bf16 v[140:155], v[176:179], v[44:47], v[140:155]
    ds_read_b128 v[176:179], v223 offset:8192
    s_waitcnt lgkmcnt(4)
    v_mfma_f32_32x32x16_bf16 v[140:155], v[180:183], v[48:51], v[140:155]
    ds_read_b128 v[180:183], v224 offset:8192
    buffer_load_dwordx4 v249, s[32:35], s79 offen offset:1024 lds
    v_mfma_f32_32x32x16_bf16 v[140:155], v[184:187], v[52:55], v[140:155]
    ds_read_b128 v[184:187], v225 offset:8192
    s_add_u32 m0, s71, 106496
    s_add_u32 s79, s69, 172032
    s_waitcnt lgkmcnt(3)
    v_mfma_f32_32x32x16_bf16 v[140:155], v[188:191], v[56:59], v[140:155]
    s_waitcnt vmcnt(12)
    s_barrier
    ds_read_b128 v[188:191], v222 offset:16384
    buffer_load_dwordx4 v246, s[24:27], s79 offen lds
    v_mfma_f32_32x32x16_bf16 v[140:155], v[172:175], v[60:63], v[140:155]
    ds_read_b128 v[172:175], v223 offset:16384
    s_waitcnt lgkmcnt(3)
    v_mfma_f32_32x32x16_bf16 v[140:155], v[176:179], v[64:67], v[140:155]
    ds_read_b128 v[176:179], v224 offset:16384
    buffer_load_dwordx4 v247, s[24:27], s79 offen offset:1024 lds
    v_mfma_f32_32x32x16_bf16 v[140:155], v[180:183], v[68:71], v[140:155]
    ds_read_b128 v[180:183], v225 offset:16384
    s_add_u32 m0, s71, 114688
    s_waitcnt lgkmcnt(3)
    v_mfma_f32_32x32x16_bf16 v[140:155], v[184:187], v[72:75], v[140:155]
    ds_read_b64_tr_b16 v[184:185], v217 offset:24576
    buffer_load_dwordx4 v246, s[24:27], s70 offen lds
    v_mfma_f32_32x32x16_bf16 v[140:155], v[188:191], v[76:79], v[140:155]
    ds_read_b64_tr_b16 v[186:187], v217 offset:25088
    ds_read_b64_tr_b16 v[188:189], v217 offset:26624
    ds_read_b64_tr_b16 v[190:191], v217 offset:27136
    s_waitcnt lgkmcnt(5)
    v_mfma_f32_32x32x16_bf16 v[140:155], v[172:175], v[80:83], v[140:155]
    ds_read_b64_tr_b16 v[172:173], v217 offset:28672
    buffer_load_dwordx4 v247, s[24:27], s70 offen offset:1024 lds
    v_mfma_f32_32x32x16_bf16 v[140:155], v[176:179], v[84:87], v[140:155]
    ds_read_b64_tr_b16 v[174:175], v217 offset:29184
    ds_read_b64_tr_b16 v[176:177], v217 offset:30720
    ds_read_b64_tr_b16 v[178:179], v217 offset:31232
    s_add_u32 m0, s71, 122880
    s_add_u32 s79, s70, 57344
    s_waitcnt lgkmcnt(6)
    v_mfma_f32_32x32x16_bf16 v[140:155], v[180:183], v[88:91], v[140:155]
    s_waitcnt vmcnt(10)
    s_barrier
    ds_read_b64_tr_b16 v[180:181], v216 offset:0
    buffer_load_dwordx4 v246, s[24:27], s79 offen lds
    v_mfma_f32_32x32x16_bf16 v[140:155], v[184:187], v[92:95], v[140:155]
    ds_read_b64_tr_b16 v[182:183], v216 offset:512
    ds_read_b64_tr_b16 v[184:185], v216 offset:2048
    ds_read_b64_tr_b16 v[186:187], v216 offset:2560
    s_waitcnt lgkmcnt(6)
    v_mfma_f32_32x32x16_bf16 v[140:155], v[188:191], v[96:99], v[140:155]
    ds_read_b64_tr_b16 v[188:189], v216 offset:4096
    buffer_load_dwordx4 v247, s[24:27], s79 offen offset:1024 lds
    v_mfma_f32_32x32x16_bf16 v[140:155], v[172:175], v[100:103], v[140:155]
    ds_read_b64_tr_b16 v[190:191], v216 offset:4608
    ds_read_b64_tr_b16 v[172:173], v216 offset:6144
    ds_read_b64_tr_b16 v[174:175], v216 offset:6656
    s_add_u32 m0, s71, 131072
    s_add_u32 s79, s70, 114688
    s_waitcnt lgkmcnt(6)
    v_mfma_f32_32x32x16_bf16 v[140:155], v[176:179], v[104:107], v[140:155]
    ds_read_b64_tr_b16 v[176:177], v216 offset:8192
    buffer_load_dwordx4 v246, s[24:27], s79 offen lds
    v_mfma_f32_32x32x16_bf16 v[156:171], v[180:183], v[12:15], 0
    ds_read_b64_tr_b16 v[178:179], v216 offset:8704
    ds_read_b64_tr_b16 v[180:181], v216 offset:10240
    ds_read_b64_tr_b16 v[182:183], v216 offset:10752
    s_waitcnt lgkmcnt(6)
    v_mfma_f32_32x32x16_bf16 v[156:171], v[184:187], v[16:19], v[156:171]
    ds_read_b64_tr_b16 v[184:185], v216 offset:12288
    ds_read_b64_tr_b16 v[186:187], v216 offset:12800
    buffer_load_dwordx4 v247, s[24:27], s79 offen offset:1024 lds
    s_mul_i32 s80, s68, 768
    s_add_u32 s80, s80, 65536
    v_perm_b32 v192, v141, v140, s85
    v_mfma_f32_32x32x16_bf16 v[156:171], v[188:191], v[20:23], v[156:171]
    ds_read_b64_tr_b16 v[188:189], v216 offset:14336
    ds_read_b64_tr_b16 v[190:191], v216 offset:14848
    s_add_u32 m0, s71, 139264
    s_mul_i32 s79, s70, 448
    v_perm_b32 v193, v143, v142, s85
    v_perm_b32 v194, v145, v144, s85
    v_perm_b32 v195, v147, v146, s85
    s_waitcnt lgkmcnt(6)
    v_mfma_f32_32x32x16_bf16 v[156:171], v[172:175], v[24:27], v[156:171]
    ds_read_b64_tr_b16 v[172:173], v216 offset:16384
    ds_read_b64_tr_b16 v[174:175], v216 offset:16896
    buffer_load_dwordx4 v248, s[28:31], s79 offen lds
    v_bitop3_b32 v192, v192, v234, s3 bitop3:0xd8
    v_bitop3_b32 v193, v193, v235, s3 bitop3:0xd8
    v_bitop3_b32 v194, v194, v236, s3 bitop3:0xd8
    v_mfma_f32_32x32x16_bf16 v[156:171], v[176:179], v[28:31], v[156:171]
    ds_read_b64_tr_b16 v[176:177], v216 offset:18432
    ds_read_b64_tr_b16 v[178:179], v216 offset:18944
    v_bitop3_b32 v195, v195, v237, s3 bitop3:0xd8
    v_perm_b32 v196, v149, v148, s85
    v_perm_b32 v197, v151, v150, s85
    s_waitcnt lgkmcnt(6)
    v_mfma_f32_32x32x16_bf16 v[156:171], v[180:183], v[32:35], v[156:171]
    ds_read_b64_tr_b16 v[180:181], v216 offset:20480
    ds_read_b64_tr_b16 v[182:183], v216 offset:20992
    buffer_load_dwordx4 v249, s[28:31], s79 offen offset:1024 lds
    v_perm_b32 v198, v153, v152, s85
    v_perm_b32 v199, v155, v154, s85
    v_bitop3_b32 v196, v196, v234, s3 bitop3:0xd8
    v_mfma_f32_32x32x16_bf16 v[156:171], v[184:187], v[36:39], v[156:171]
    ds_read_b64_tr_b16 v[184:185], v216 offset:22528
    ds_read_b64_tr_b16 v[186:187], v216 offset:23040
    s_add_u32 m0, s71, 147456
    s_mul_i32 s79, s70, 448
    v_bitop3_b32 v197, v197, v235, s3 bitop3:0xd8
    v_bitop3_b32 v198, v198, v236, s3 bitop3:0xd8
    v_bitop3_b32 v199, v199, v237, s3 bitop3:0xd8
    s_waitcnt lgkmcnt(6)
    v_mfma_f32_32x32x16_bf16 v[156:171], v[188:191], v[40:43], v[156:171]
    s_waitcnt vmcnt(8)
    s_barrier
    ds_read_b128 v[188:191], v218 offset:24576
    buffer_load_dwordx4 v248, s[32:35], s79 offen lds
    buffer_store_dwordx4 v[192:195], v239, s[36:39], s80 offen offset:0 sc1
    buffer_store_dwordx4 v[196:199], v239, s[36:39], s80 offen offset:1024 sc1
    v_mfma_f32_32x32x16_bf16 v[156:171], v[172:175], v[44:47], v[156:171]
    ds_read_b128 v[172:175], v219 offset:24576
    s_waitcnt lgkmcnt(4)
    v_mfma_f32_32x32x16_bf16 v[156:171], v[176:179], v[48:51], v[156:171]
    ds_read_b128 v[176:179], v220 offset:24576
    buffer_load_dwordx4 v249, s[32:35], s79 offen offset:1024 lds
    v_mfma_f32_32x32x16_bf16 v[156:171], v[180:183], v[52:55], v[156:171]
    ds_read_b128 v[180:183], v221 offset:24576
    s_add_u32 m0, s71, 155648
    s_add_u32 s79, s70, 172032
    s_waitcnt lgkmcnt(3)
    v_mfma_f32_32x32x16_bf16 v[156:171], v[184:187], v[56:59], v[156:171]
    ds_read_b128 v[184:187], v218 offset:32768
    buffer_load_dwordx4 v246, s[24:27], s79 offen lds
    v_mfma_f32_32x32x16_bf16 v[156:171], v[188:191], v[60:63], v[156:171]
    ds_read_b128 v[188:191], v219 offset:32768
    s_waitcnt lgkmcnt(3)
    v_mfma_f32_32x32x16_bf16 v[156:171], v[172:175], v[64:67], v[156:171]
    ds_read_b128 v[172:175], v220 offset:32768
    buffer_load_dwordx4 v247, s[24:27], s79 offen offset:1024 lds
    v_mfma_f32_32x32x16_bf16 v[156:171], v[176:179], v[68:71], v[156:171]
    ds_read_b128 v[176:179], v221 offset:32768
    s_waitcnt lgkmcnt(3)
    v_mfma_f32_32x32x16_bf16 v[156:171], v[180:183], v[72:75], v[156:171]
    ds_read_b64_tr_b16 v[180:181], v216 offset:40960
    ds_read_b64_tr_b16 v[182:183], v216 offset:41472
    v_mfma_f32_32x32x16_bf16 v[156:171], v[184:187], v[76:79], v[156:171]
    ds_read_b64_tr_b16 v[184:185], v216 offset:43008
    ds_read_b64_tr_b16 v[186:187], v216 offset:43520
    s_waitcnt lgkmcnt(5)
    v_mfma_f32_32x32x16_bf16 v[156:171], v[188:191], v[80:83], v[156:171]
    ds_read_b64_tr_b16 v[188:189], v216 offset:45056
    ds_read_b64_tr_b16 v[190:191], v216 offset:45568
    v_mfma_f32_32x32x16_bf16 v[156:171], v[172:175], v[84:87], v[156:171]
    ds_read_b64_tr_b16 v[172:173], v216 offset:47104
    ds_read_b64_tr_b16 v[174:175], v216 offset:47616
    s_waitcnt lgkmcnt(6)
    v_mfma_f32_32x32x16_bf16 v[156:171], v[176:179], v[88:91], v[156:171]
    v_mfma_f32_32x32x16_bf16 v[156:171], v[180:183], v[92:95], v[156:171]
    s_waitcnt lgkmcnt(2)
    v_mfma_f32_32x32x16_bf16 v[156:171], v[184:187], v[96:99], v[156:171]
    v_mfma_f32_32x32x16_bf16 v[156:171], v[188:191], v[100:103], v[156:171]
    s_waitcnt lgkmcnt(0)
    v_mfma_f32_32x32x16_bf16 v[156:171], v[172:175], v[104:107], v[156:171]
    s_mul_i32 s80, s69, 768
    s_add_u32 s80, s80, 81920
    s_nop 9
    v_perm_b32 v200, v157, v156, s85
    v_perm_b32 v201, v159, v158, s85
    v_perm_b32 v202, v161, v160, s85
    v_perm_b32 v203, v163, v162, s85
    v_bitop3_b32 v200, v200, v234, s3 bitop3:0xd8
    v_bitop3_b32 v201, v201, v235, s3 bitop3:0xd8
    v_bitop3_b32 v202, v202, v236, s3 bitop3:0xd8
    v_bitop3_b32 v203, v203, v237, s3 bitop3:0xd8
    buffer_store_dwordx4 v[200:203], v239, s[36:39], s80 offen offset:0 sc1
    v_perm_b32 v204, v165, v164, s85
    v_perm_b32 v205, v167, v166, s85
    v_perm_b32 v206, v169, v168, s85
    v_perm_b32 v207, v171, v170, s85
    v_bitop3_b32 v204, v204, v234, s3 bitop3:0xd8
    v_bitop3_b32 v205, v205, v235, s3 bitop3:0xd8
    v_bitop3_b32 v206, v206, v236, s3 bitop3:0xd8
    v_bitop3_b32 v207, v207, v237, s3 bitop3:0xd8
    buffer_store_dwordx4 v[204:207], v239, s[36:39], s80 offen offset:1024 sc1
    s_waitcnt vmcnt(8)
    s_barrier
    ds_read_b64_tr_b16 v[176:177], v216 offset:49152
    ds_read_b64_tr_b16 v[178:179], v216 offset:49664
    ds_read_b64_tr_b16 v[180:181], v216 offset:51200
    ds_read_b64_tr_b16 v[182:183], v216 offset:51712
    ds_read_b64_tr_b16 v[184:185], v216 offset:53248
    ds_read_b64_tr_b16 v[186:187], v216 offset:53760
    ds_read_b64_tr_b16 v[188:189], v216 offset:55296
    ds_read_b64_tr_b16 v[190:191], v216 offset:55808
    ds_read_b64_tr_b16 v[172:173], v216 offset:57344
    ds_read_b64_tr_b16 v[174:175], v216 offset:57856
    s_waitcnt lgkmcnt(8)
    v_mfma_f32_32x32x16_bf16 v[108:123], v[176:179], v[12:15], 0
L_pad2:
    s_cmp_eq_u32 s51, 1
    s_cbranch_scc1 L_hopd
    ds_read_b64_tr_b16 v[176:177], v216 offset:59392
    ds_read_b64_tr_b16 v[178:179], v216 offset:59904
    s_waitcnt lgkmcnt(6)
    v_mfma_f32_32x32x16_bf16 v[108:123], v[180:183], v[16:19], v[108:123]
    ds_read_b64_tr_b16 v[180:181], v216 offset:61440
    ds_read_b64_tr_b16 v[182:183], v216 offset:61952
    v_mfma_f32_32x32x16_bf16 v[108:123], v[184:187], v[20:23], v[108:123]
    ds_read_b64_tr_b16 v[184:185], v216 offset:63488
    ds_read_b64_tr_b16 v[186:187], v216 offset:64000
    s_waitcnt lgkmcnt(6)
    v_mfma_f32_32x32x16_bf16 v[108:123], v[188:191], v[24:27], v[108:123]
    ds_read_b64_tr_b16 v[188:189], v217 offset:0
    ds_read_b64_tr_b16 v[190:191], v217 offset:512
    v_mfma_f32_32x32x16_bf16 v[108:123], v[172:175], v[28:31], v[108:123]
    ds_read_b64_tr_b16 v[172:173], v217 offset:2048
    ds_read_b64_tr_b16 v[174:175], v217 offset:2560
    s_waitcnt lgkmcnt(6)
    v_mfma_f32_32x32x16_bf16 v[108:123], v[176:179], v[32:35], v[108:123]
    ds_read_b64_tr_b16 v[176:177], v217 offset:4096
    ds_read_b64_tr_b16 v[178:179], v217 offset:4608
    v_mfma_f32_32x32x16_bf16 v[108:123], v[180:183], v[36:39], v[108:123]
    ds_read_b64_tr_b16 v[180:181], v217 offset:6144
    ds_read_b64_tr_b16 v[182:183], v217 offset:6656
    s_waitcnt lgkmcnt(6)
    v_mfma_f32_32x32x16_bf16 v[108:123], v[184:187], v[40:43], v[108:123]
    ds_read_b128 v[184:187], v222 offset:8192
    v_mfma_f32_32x32x16_bf16 v[108:123], v[188:191], v[44:47], v[108:123]
    ds_read_b128 v[188:191], v223 offset:8192
    s_waitcnt lgkmcnt(4)
    v_mfma_f32_32x32x16_bf16 v[108:123], v[172:175], v[48:51], v[108:123]
    ds_read_b128 v[172:175], v224 offset:8192
    v_mfma_f32_32x32x16_bf16 v[108:123], v[176:179], v[52:55], v[108:123]
    ds_read_b128 v[176:179], v225 offset:8192
    s_waitcnt lgkmcnt(3)
    v_mfma_f32_32x32x16_bf16 v[108:123], v[180:183], v[56:59], v[108:123]
    s_waitcnt vmcnt(2)
    s_barrier
    ds_read_b128 v[180:183], v222 offset:16384
    v_mfma_f32_32x32x16_bf16 v[108:123], v[184:187], v[60:63], v[108:123]
    ds_read_b128 v[184:187], v223 offset:16384
    s_waitcnt lgkmcnt(3)
    v_mfma_f32_32x32x16_bf16 v[108:123], v[188:191], v[64:67], v[108:123]
    ds_read_b128 v[188:191], v224 offset:16384
    v_mfma_f32_32x32x16_bf16 v[108:123], v[172:175], v[68:71], v[108:123]
    ds_read_b128 v[172:175], v225 offset:16384
    s_waitcnt lgkmcnt(3)
    v_mfma_f32_32x32x16_bf16 v[108:123], v[176:179], v[72:75], v[108:123]
    ds_read_b64_tr_b16 v[176:177], v217 offset:24576
    ds_read_b64_tr_b16 v[178:179], v217 offset:25088
    v_mfma_f32_32x32x16_bf16 v[108:123], v[180:183], v[76:79], v[108:123]
    ds_read_b64_tr_b16 v[180:181], v217 offset:26624
    ds_read_b64_tr_b16 v[182:183], v217 offset:27136
    s_waitcnt lgkmcnt(5)
    v_mfma_f32_32x32x16_bf16 v[108:123], v[184:187], v[80:83], v[108:123]
    ds_read_b64_tr_b16 v[184:185], v217 offset:28672
    ds_read_b64_tr_b16 v[186:187], v217 offset:29184
    v_mfma_f32_32x32x16_bf16 v[108:123], v[188:191], v[84:87], v[108:123]
    ds_read_b64_tr_b16 v[188:189], v217 offset:30720
    ds_read_b64_tr_b16 v[190:191], v217 offset:31232
    s_waitcnt lgkmcnt(6)
    v_mfma_f32_32x32x16_bf16 v[108:123], v[172:175], v[88:91], v[108:123]
    v_mfma_f32_32x32x16_bf16 v[108:123], v[176:179], v[92:95], v[108:123]
    s_waitcnt lgkmcnt(2)
    v_mfma_f32_32x32x16_bf16 v[108:123], v[180:183], v[96:99], v[108:123]
    v_mfma_f32_32x32x16_bf16 v[108:123], v[184:187], v[100:103], v[108:123]
    s_waitcnt lgkmcnt(0)
    v_mfma_f32_32x32x16_bf16 v[108:123], v[188:191], v[104:107], v[108:123]
    s_nop 11
    ds_write_b128 v238, v[108:111]
    ds_write_b128 v4, v[112:115]
    ds_write_b128 v5, v[116:119]
    ds_write_b128 v6, v[120:123]
    s_waitcnt lgkmcnt(0)
    s_barrier
    s_endpgm
.p2align 12
L_S:
    s_load_dwordx2 s[36:37], s[0:1], 120
    s_load_dwordx2 s[40:41], s[0:1], 104
    s_mov_b32 s38, 33554432
    s_mov_b32 s39, 0x20000
    s_mov_b32 s42, 3670016
    s_mov_b32 s43, 0x20000
    v_and_b32 v6, 7, v2
    v_lshrrev_b32 v7, 3, v2
    v_xor_b32 v6, v6, v7
    v_lshrrev_b32 v8, 5, v2
    v_and_b32 v9, 15, v2
    v_lshrrev_b32 v213, 4, v2
    v_lshlrev_b32 v10, 4, v2
    v_lshrrev_b32 v3, 1, v9
    v_xor_b32 v3, v3, v213
    v_lshlrev_b32 v3, 4, v3
    v_lshl_add_u32 v156, v9, 7, v3
    v_xor_b32 v157, 64, v156
    v_add_u32 v163, s71, v156
    v_add_u32 v158, 65536, v163
    v_add_u32 v160, 131072, v163
    v_add_u32 v164, s71, v157
    v_add_u32 v159, 65536, v164
    v_add_u32 v161, 131072, v164
    v_lshlrev_b32 v162, 4, v213
    v_lshl_add_u32 v3, s62, 4, v9
    v_lshlrev_b32 v218, 1, v3
    s_waitcnt lgkmcnt(0)
    s_load_dword s58, s[36:37], 0
    s_lshl_b32 s79, s61, 14
    s_add_u32 s79, s79, 4096
    s_add_u32 s8, s36, s79
    s_addc_u32 s9, s37, 0
    s_mov_b32 s10, 16384
    s_mov_b32 s11, 0x20000
    s_lshl_b32 s79, s60, 2
    s_add_u32 s79, s79, s62
    s_lshl_b32 s79, s79, 7
    v_and_b32 v5, 7, v2
    v_lshl_add_u32 v5, v5, 4, s79
    v_bfe_u32 v196, v2, 3, 1
    v_cmp_eq_u32 vcc, 3, v213
    v_lshl_add_u32 v4, v196, 3, v5
    v_lshlrev_b32 v198, 9, v7
    v_cndmask_b32 v206, -1, v4, vcc
    v_sub_u32 v5, v5, v198
    v_subrev_u32 v198, 512, v5
    v_not_b32 v202, v198
    v_lshrrev_b32 v202, 24, v202
    v_subrev_u32 v199, 4608, v5
    v_not_b32 v203, v199
    v_lshrrev_b32 v203, 24, v203
    v_subrev_u32 v200, 8704, v5
    v_not_b32 v204, v200
    v_lshrrev_b32 v204, 24, v204
    v_subrev_u32 v201, 12800, v5
    v_not_b32 v205, v201
    v_lshrrev_b32 v205, 24, v205
    v_lshlrev_b32 v5, 7, v3
    v_bfe_u32 v4, v2, 1, 1
    v_lshl_add_u32 v5, v4, 6, v5
    v_bfe_u32 v4, v2, 2, 1
    v_and_b32 v1, 1, v2
    v_lshl_add_u32 v4, v4, 1, v1
    v_xor_b32 v4, v4, v213
    v_lshl_add_u32 v211, v4, 4, v5
    v_xor_b32 v212, 64, v211
    s_mul_i32 s79, s60, 1792
    s_add_u32 s79, s79, 196608
    s_lshl_b32 s80, s61, 8
    s_add_u32 s80, s80, s79
    v_and_b32 v4, 3, v2
    v_bfe_u32 v5, v2, 2, 2
    v_lshlrev_b32 v226, 3, v5
    v_lshl_add_u32 v4, v4, 2, v5
    v_lshl_add_u32 v4, s62, 4, v4
    v_lshl_add_u32 v222, v4, 2, s80
    v_cmp_gt_u32 vcc, 48, v2
    v_add_u32 v223, s79, v10
    v_lshlrev_b32 v232, 3, v2
    v_mov_b32 v4, 2147483648
    v_cndmask_b32 v224, v4, v223, vcc
    v_cndmask_b32 v225, 0, -1, vcc
    s_lshl_b32 s80, s84, 6
    v_lshl_add_u32 v217, v6, 3, s80
    v_lshlrev_b32 v209, 1, v217
    v_lshl_add_u32 v209, s61, 8, v209
    v_and_b32 v3, 3, v7
    v_lshl_add_u32 v5, v8, 4, v3
    v_lshl_add_u32 v5, s83, 3, v5
    v_lshlrev_b32 v210, 3, v5
    v_lshl_add_u32 v5, s60, 6, v5
    s_mov_b32 s79, 1792
    v_mad_u32_u24 v209, v5, s79, v209
    v_bfe_u32 v4, v6, 1, 1
    v_lshl_add_u32 v194, v3, 1, v4
    v_lshlrev_b32 v194, 2, v194
    v_lshl_add_u32 v5, v7, 4, s71
    v_lshl_add_u32 v5, v4, 3, v5
    v_and_b32 v3, 1, v6
    v_mul_u32_u24 v4, 576, v3
    v_xor_b32 v5, v5, v4
    v_lshrrev_b32 v4, 2, v6
    v_mul_u32_u24 v4, 1152, v4
    v_xor_b32 v214, v5, v4
    v_xor_b32 v215, 128, v214
    v_lshlrev_b32 v5, 7, v7
    v_lshl_add_u32 v5, s83, 12, v5
    v_lshl_add_u32 v5, v3, 3, v5
    v_lshrrev_b32 v4, 1, v6
    v_lshl_add_u32 v4, s84, 2, v4
    v_lshrrev_b32 v3, 1, v7
    v_xor_b32 v4, v4, v3
    v_lshl_add_u32 v219, v4, 4, v5
    v_xor_b32 v220, 64, v219
    s_mul_i32 s80, s60, 21846
    s_lshr_b32 s80, s80, 16
    s_mul_i32 s80, s80, 32768
    s_mul_i32 s81, s60, 688128
    s_add_u32 s81, s81, s80
    s_add_u32 s81, s81, 2097152
    s_mul_i32 s80, s61, 98304
    s_add_u32 s81, s81, s80
    s_add_u32 s81, s81, s71
    s_add_u32 s78, s81, 1984
    v_lshlrev_b32 v5, 6, v8
    v_xor_b32 v5, v5, v10
    v_add_u32 v207, s81, v5
    v_xor_b32 v208, 128, v207
    v_lshl_add_u32 v221, s62, 12, v10
    v_add_u32 v221, 65536, v221
    s_lshl_b32 s24, s60, 7
    s_add_u32 s24, s24, 131072
    s_or_b32 s25, s61, s62
    s_cselect_b32 s25, 2147483648, s24
    s_mov_b32 s26, 0
    v_mov_b32 v216, 0xffff0000
    v_mov_b32 v235, 0
    s_mov_b32 s82, 65536
    s_mov_b32 s3, 0x00010001
    s_mov_b32 s85, 0x10000
    s_waitcnt lgkmcnt(0)
    s_or_b32 s80, s58, 0x55555555
    s_add_u32 s80, s80, 1
    s_and_b32 s80, s80, 0xaaaaaaaa
    s_andn2_b32 s58, 0x55555555, s58
    s_or_b32 s58, s58, s80
    v_mov_b32 v170, s58
    v_bfe_u32 v226, v170, v226, 8
    v_lshlrev_b32 v3, 4, v196
    v_lshrrev_b32 v3, v3, v170
    v_and_b32 v196, 0xff, v3
    v_bfe_u32 v197, v3, 8, 8
    v_lshrrev_b32 v5, v194, v170
    v_bfe_u32 v3, v5, 0, 1
    v_bfe_u32 v4, v5, 1, 1
    v_lshl_or_b32 v194, v4, 16, v3
    v_bfe_u32 v3, v5, 2, 1
    v_bfe_u32 v4, v5, 3, 1
    v_lshl_or_b32 v195, v4, 16, v3
    s_bfe_u32 s64, s58, 65536
    s_bfe_u32 s79, s58, 65537
    s_lshl_b32 s79, s79, 16
    s_or_b32 s64, s64, s79
    s_bfe_u32 s28, s58, 524288
    s_bfe_u32 s65, s58, 65538
    s_bfe_u32 s79, s58, 65539
    s_lshl_b32 s79, s79, 16
    s_or_b32 s65, s65, s79
    s_bfe_u32 s29, s58, 524296
    s_bfe_u32 s66, s58, 65540
    s_bfe_u32 s79, s58, 65541
    s_lshl_b32 s79, s79, 16
    s_or_b32 s66, s66, s79
    s_bfe_u32 s30, s58, 524304
    s_bfe_u32 s67, s58, 65542
    s_bfe_u32 s79, s58, 65543
    s_lshl_b32 s79, s79, 16
    s_or_b32 s67, s67, s79
    s_bfe_u32 s31, s58, 524312
    s_barrier
    ds_read_b128 v[76:79], v158 offset:0
    ds_read_b128 v[60:63], v156 offset:0
    ds_read_b128 v[80:83], v158 offset:8192
    ds_read_b128 v[64:67], v156 offset:2048
    ds_read_b128 v[68:71], v156 offset:4096
    ds_read_b128 v[72:75], v156 offset:6144
    ds_read_b128 v[140:143], v162 offset:59392
    ds_read_b128 v[144:147], v163 offset:0
    ds_read_u16 v165, v218 offset:58368
    ds_read_u16 v166, v218 offset:58624
    ds_read_u16 v167, v218 offset:58880
    ds_read_b64 v[168:169], v217 offset:59136
    ds_read_b128 v[100:103], v159 offset:0
    s_waitcnt lgkmcnt(9)
    v_mfma_f32_16x16x32_bf16 v[12:15], v[60:63], v[76:79], 0
    ds_read_b128 v[84:87], v157 offset:0
    v_mfma_f32_16x16x32_bf16 v[28:31], v[60:63], v[80:83], 0
    ds_read_b128 v[104:107], v159 offset:8192
    v_mfma_f32_16x16x32_bf16 v[16:19], v[64:67], v[76:79], 0
    ds_read_b128 v[88:91], v157 offset:2048
    v_mfma_f32_16x16x32_bf16 v[32:35], v[64:67], v[80:83], 0
    ds_read_b128 v[92:95], v157 offset:4096
    s_waitcnt lgkmcnt(11)
    v_mfma_f32_16x16x32_bf16 v[20:23], v[68:71], v[76:79], 0
    ds_read_b128 v[96:99], v157 offset:6144
    v_mfma_f32_16x16x32_bf16 v[36:39], v[68:71], v[80:83], 0
    ds_read_b128 v[148:151], v162 offset:59456
    v_mfma_f32_16x16x32_bf16 v[24:27], v[72:75], v[76:79], 0
    ds_read_b128 v[152:155], v164 offset:0
    v_mfma_f32_16x16x32_bf16 v[40:43], v[72:75], v[80:83], 0
    s_mov_b32 s51, 1
    s_cmp_eq_u32 s62, 0
    s_cbranch_scc1 L_pad0
    s_cmp_eq_u32 s62, 1
    s_cbranch_scc1 L_pad1
    s_cmp_eq_u32 s62, 2
    s_cbranch_scc1 L_pad2
    s_branch L_pad3
L_hopd:
    s_mov_b32 s51, 0
    s_barrier
    ds_read_b128 v[76:79], v158 offset:16384
    s_waitcnt lgkmcnt(5)
    v_mfma_f32_16x16x32_bf16 v[12:15], v[84:87], v[100:103], v[12:15]
    ds_read_b128 v[60:63], v156 offset:8192
    v_mfma_f32_16x16x32_bf16 v[28:31], v[84:87], v[104:107], v[28:31]
    v_lshlrev_b32 v165, 16, v165
    v_lshlrev_b32 v166, 16, v166
    ds_read_b128 v[80:83], v158 offset:24576
    v_mfma_f32_16x16x32_bf16 v[16:19], v[88:91], v[100:103], v[16:19]
    v_lshlrev_b32 v167, 16, v167
    v_mul_f32 v167, 1069066811, v167
    ds_read_b128 v[64:67], v156 offset:10240
    v_mfma_f32_16x16x32_bf16 v[32:35], v[88:91], v[104:107], v[32:35]
    v_exp_f32 v167, v167
    s_nop 0
    v_cvt_pk_bf16_f32 v167, v167, v167
    ds_read_b128 v[68:71], v156 offset:12288
    s_waitcnt lgkmcnt(7)
    v_mfma_f32_16x16x32_bf16 v[20:23], v[92:95], v[100:103], v[20:23]
    ds_read_b128 v[72:75], v156 offset:14336
    v_mfma_f32_16x16x32_bf16 v[36:39], v[92:95], v[104:107], v[36:39]
    v_lshlrev_b32 v167, 16, v167
    v_mul_f32 v171, v167, v165
    v_mfma_f32_16x16x32_bf16 v[24:27], v[96:99], v[100:103], v[24:27]
    v_mul_f32 v172, v167, v166
    v_mul_f32 v171, 1069066811, v171
    v_mfma_f32_16x16x32_bf16 v[40:43], v[96:99], v[104:107], v[40:43]
    v_mul_f32 v172, 1042479491, v172
    v_exp_f32 v3, v171
    ds_read_b128 v[100:103], v159 offset:16384
    s_waitcnt lgkmcnt(3)
    v_mfma_f32_16x16x32_bf16 v[12:15], v[60:63], v[76:79], v[12:15]
    v_mov_b32 v48, 0x3f803f80
    v_mov_b32 v49, 0x3f803f80
    ds_read_b128 v[84:87], v157 offset:8192
    v_mfma_f32_16x16x32_bf16 v[28:31], v[60:63], v[80:83], v[28:31]
    v_mov_b32 v50, 0x3f803f80
    v_mov_b32 v51, 0x3f803f80
    ds_read_b128 v[104:107], v159 offset:24576
    v_mfma_f32_16x16x32_bf16 v[16:19], v[64:67], v[76:79], v[16:19]
    v_lshlrev_b32 v52, 16, v140
    v_lshlrev_b32 v53, 16, v144
    ds_read_b128 v[88:91], v157 offset:10240
    v_mfma_f32_16x16x32_bf16 v[32:35], v[64:67], v[80:83], v[32:35]
    v_and_b32 v140, v216, v140
    v_and_b32 v144, v216, v144
    ds_read_b128 v[92:95], v157 offset:12288
    s_waitcnt lgkmcnt(5)
    v_mfma_f32_16x16x32_bf16 v[20:23], v[68:71], v[76:79], v[20:23]
    v_mul_f32 v52, v52, v53
    v_mul_f32 v140, v140, v144
    ds_read_b128 v[96:99], v157 offset:14336
    v_mfma_f32_16x16x32_bf16 v[36:39], v[68:71], v[80:83], v[36:39]
    v_cvt_pk_bf16_f32 v140, v52, v140
    v_lshlrev_b32 v52, 16, v141
    v_mfma_f32_16x16x32_bf16 v[24:27], v[72:75], v[76:79], v[24:27]
    v_lshlrev_b32 v53, 16, v145
    v_and_b32 v141, v216, v141
    v_mfma_f32_16x16x32_bf16 v[40:43], v[72:75], v[80:83], v[40:43]
    v_and_b32 v145, v216, v145
    v_mul_f32 v52, v52, v53
    s_barrier
    ds_read_b128 v[76:79], v158 offset:32768
    s_waitcnt lgkmcnt(3)
    v_mfma_f32_16x16x32_bf16 v[12:15], v[84:87], v[100:103], v[12:15]
    v_mul_f32 v141, v141, v145
    v_cvt_pk_bf16_f32 v141, v52, v141
    ds_read_b128 v[60:63], v156 offset:16384
    v_mfma_f32_16x16x32_bf16 v[28:31], v[84:87], v[104:107], v[28:31]
    v_lshlrev_b32 v52, 16, v142
    v_lshlrev_b32 v53, 16, v146
    ds_read_b128 v[80:83], v158 offset:40960
    v_mfma_f32_16x16x32_bf16 v[16:19], v[88:91], v[100:103], v[16:19]
    v_and_b32 v142, v216, v142
    v_and_b32 v146, v216, v146
    ds_read_b128 v[64:67], v156 offset:18432
    v_mfma_f32_16x16x32_bf16 v[32:35], v[88:91], v[104:107], v[32:35]
    v_mul_f32 v52, v52, v53
    v_mul_f32 v142, v142, v146
    ds_read_b128 v[68:71], v156 offset:20480
    s_waitcnt lgkmcnt(5)
    v_mfma_f32_16x16x32_bf16 v[20:23], v[92:95], v[100:103], v[20:23]
    v_cvt_pk_bf16_f32 v142, v52, v142
    v_lshlrev_b32 v52, 16, v143
    ds_read_b128 v[72:75], v156 offset:22528
    v_mfma_f32_16x16x32_bf16 v[36:39], v[92:95], v[104:107], v[36:39]
    v_lshlrev_b32 v53, 16, v147
    v_and_b32 v143, v216, v143
    v_mfma_f32_16x16x32_bf16 v[24:27], v[96:99], v[100:103], v[24:27]
    v_and_b32 v147, v216, v147
    v_mul_f32 v52, v52, v53
    v_mfma_f32_16x16x32_bf16 v[40:43], v[96:99], v[104:107], v[40:43]
    v_mul_f32 v143, v143, v147
    v_cvt_pk_bf16_f32 v143, v52, v143
    ds_read_b128 v[100:103], v159 offset:32768
    s_waitcnt lgkmcnt(3)
    v_mfma_f32_16x16x32_bf16 v[12:15], v[60:63], v[76:79], v[12:15]
    v_lshlrev_b32 v52, 16, v148
    v_lshlrev_b32 v53, 16, v152
    ds_read_b128 v[84:87], v157 offset:16384
    v_mfma_f32_16x16x32_bf16 v[28:31], v[60:63], v[80:83], v[28:31]
    v_and_b32 v148, v216, v148
    v_and_b32 v152, v216, v152
    ds_read_b128 v[104:107], v159 offset:40960
    v_mfma_f32_16x16x32_bf16 v[16:19], v[64:67], v[76:79], v[16:19]
    v_mul_f32 v52, v52, v53
    v_mul_f32 v148, v148, v152
    ds_read_b128 v[88:91], v157 offset:18432
    v_mfma_f32_16x16x32_bf16 v[32:35], v[64:67], v[80:83], v[32:35]
    v_cvt_pk_bf16_f32 v148, v52, v148
    v_lshlrev_b32 v52, 16, v149
    ds_read_b128 v[92:95], v157 offset:20480
    s_waitcnt lgkmcnt(5)
    v_mfma_f32_16x16x32_bf16 v[20:23], v[68:71], v[76:79], v[20:23]
    v_lshlrev_b32 v53, 16, v153
    v_and_b32 v149, v216, v149
    ds_read_b128 v[96:99], v157 offset:22528
    v_mfma_f32_16x16x32_bf16 v[36:39], v[68:71], v[80:83], v[36:39]
    v_and_b32 v153, v216, v153
    v_mul_f32 v52, v52, v53
    v_mfma_f32_16x16x32_bf16 v[24:27], v[72:75], v[76:79], v[24:27]
    v_mul_f32 v149, v149, v153
    v_cvt_pk_bf16_f32 v149, v52, v149
    v_mfma_f32_16x16x32_bf16 v[40:43], v[72:75], v[80:83], v[40:43]
    v_lshlrev_b32 v52, 16, v150
    v_lshlrev_b32 v53, 16, v154
    s_barrier
    ds_read_b128 v[76:79], v158 offset:49152
    s_waitcnt lgkmcnt(3)
    v_mfma_f32_16x16x32_bf16 v[12:15], v[84:87], v[100:103], v[12:15]
    v_and_b32 v150, v216, v150
    v_and_b32 v154, v216, v154
    ds_read_b128 v[60:63], v156 offset:24576
    v_mfma_f32_16x16x32_bf16 v[28:31], v[84:87], v[104:107], v[28:31]
    v_mul_f32 v52, v52, v53
    v_mul_f32 v150, v150, v154
    ds_read_b128 v[80:83], v158 offset:57344
    v_mfma_f32_16x16x32_bf16 v[16:19], v[88:91], v[100:103], v[16:19]
    v_cvt_pk_bf16_f32 v150, v52, v150
    v_lshlrev_b32 v52, 16, v151
    ds_read_b128 v[64:67], v156 offset:26624
    v_mfma_f32_16x16x32_bf16 v[32:35], v[88:91], v[104:107], v[32:35]
    v_lshlrev_b32 v53, 16, v155
    v_and_b32 v151, v216, v151
    ds_read_b128 v[68:71], v156 offset:28672
    s_waitcnt lgkmcnt(5)
    v_mfma_f32_16x16x32_bf16 v[20:23], v[92:95], v[100:103], v[20:23]
    v_and_b32 v155, v216, v155
    ds_read_b128 v[72:75], v156 offset:30720
    v_mfma_f32_16x16x32_bf16 v[36:39], v[92:95], v[104:107], v[36:39]
    v_mul_f32 v52, v52, v53
    v_mfma_f32_16x16x32_bf16 v[24:27], v[96:99], v[100:103], v[24:27]
    v_mul_f32 v151, v151, v155
    v_mfma_f32_16x16x32_bf16 v[40:43], v[96:99], v[104:107], v[40:43]
    v_cvt_pk_bf16_f32 v151, v52, v151
    v_mfma_f32_16x16x32_bf16 v[44:47], v[48:51], v[140:143], 0
    s_nop 0
    v_mfma_f32_16x16x32_bf16 v[44:47], v[48:51], v[148:151], v[44:47]
    ds_read_b128 v[100:103], v159 offset:49152
    s_waitcnt lgkmcnt(3)
    v_mfma_f32_16x16x32_bf16 v[12:15], v[60:63], v[76:79], v[12:15]
    ds_read_b128 v[84:87], v157 offset:24576
    v_mfma_f32_16x16x32_bf16 v[28:31], v[60:63], v[80:83], v[28:31]
    v_fract_f32 v4, v172
    v_cos_f32 v173, v4
    ds_read_b128 v[104:107], v159 offset:57344
    v_mfma_f32_16x16x32_bf16 v[16:19], v[64:67], v[76:79], v[16:19]
    v_sin_f32 v174, v4
    v_mul_f32 v173, v173, v3
    ds_read_b128 v[88:91], v157 offset:26624
    v_mfma_f32_16x16x32_bf16 v[32:35], v[64:67], v[80:83], v[32:35]
    v_mul_f32 v174, v174, v3
    v_sub_f32 v175, 0, v174
    ds_read_b128 v[92:95], v157 offset:28672
    s_waitcnt lgkmcnt(5)
    v_mfma_f32_16x16x32_bf16 v[20:23], v[68:71], v[76:79], v[20:23]
    ds_read_b128 v[96:99], v157 offset:30720
    v_mfma_f32_16x16x32_bf16 v[36:39], v[68:71], v[80:83], v[36:39]
    v_mul_f32 v3, 0x41800000, v171
    v_mul_f32 v4, 0x41800000, v172
    v_mfma_f32_16x16x32_bf16 v[24:27], v[72:75], v[76:79], v[24:27]
    v_exp_f32 v3, v3
    v_fract_f32 v4, v4
    v_mfma_f32_16x16x32_bf16 v[40:43], v[72:75], v[80:83], v[40:43]
    v_cos_f32 v178, v4
    v_sin_f32 v179, v4
    v_and_b32 v44, 0xffffff00, v44
    v_or_b32 v44, v44, v226
    buffer_store_dword v44, v222, s[36:39], 0 offen sc1
    s_barrier
    ds_read_b128 v[76:79], v160 offset:0
    s_waitcnt lgkmcnt(3)
    v_mfma_f32_16x16x32_bf16 v[12:15], v[84:87], v[100:103], v[12:15]
    ds_read_b128 v[60:63], v156 offset:32768
    v_mfma_f32_16x16x32_bf16 v[28:31], v[84:87], v[104:107], v[28:31]
    v_mul_f32 v178, v178, v3
    v_mul_f32 v179, v179, v3
    ds_read_b128 v[80:83], v160 offset:8192
    v_mfma_f32_16x16x32_bf16 v[16:19], v[88:91], v[100:103], v[16:19]
    v_mul_f32 v3, v165, v165
    v_fmac_f32 v3, v166, v166
    ds_read_b128 v[64:67], v156 offset:34816
    v_mfma_f32_16x16x32_bf16 v[32:35], v[88:91], v[104:107], v[32:35]
    v_rcp_f32 v3, v3
    v_add_f32 v4, -1.0, v173
    ds_read_b128 v[68:71], v156 offset:36864
    s_waitcnt lgkmcnt(5)
    v_mfma_f32_16x16x32_bf16 v[20:23], v[92:95], v[100:103], v[20:23]
    ds_read_b128 v[72:75], v156 offset:38912
    v_mfma_f32_16x16x32_bf16 v[36:39], v[92:95], v[104:107], v[36:39]
    v_mul_f32 v176, v4, v165
    v_fmac_f32 v176, v174, v166
    v_mfma_f32_16x16x32_bf16 v[24:27], v[96:99], v[100:103], v[24:27]
    v_mul_f32 v176, v176, v3
    v_mul_f32 v177, v174, v165
    v_mfma_f32_16x16x32_bf16 v[40:43], v[96:99], v[104:107], v[40:43]
    v_fma_f32 v177, -v4, v166, v177
    v_mul_f32 v177, v177, v3
    ds_read_b128 v[100:103], v161 offset:0
    s_waitcnt lgkmcnt(3)
    v_mfma_f32_16x16x32_bf16 v[12:15], v[60:63], v[76:79], v[12:15]
    ds_read_b128 v[84:87], v157 offset:32768
    v_mfma_f32_16x16x32_bf16 v[28:31], v[60:63], v[80:83], v[28:31]
    v_lshlrev_b32 v5, 4, v213
    v_cvt_f32_i32 v5, v5
    ds_read_b128 v[104:107], v161 offset:8192
    v_mfma_f32_16x16x32_bf16 v[16:19], v[64:67], v[76:79], v[16:19]
    v_mul_f32 v3, v5, v171
    v_mul_f32 v4, v5, v172
    ds_read_b128 v[88:91], v157 offset:34816
    v_mfma_f32_16x16x32_bf16 v[32:35], v[64:67], v[80:83], v[32:35]
    v_exp_f32 v3, v3
    v_fract_f32 v4, v4
    ds_read_b128 v[92:95], v157 offset:36864
    s_waitcnt lgkmcnt(5)
    v_mfma_f32_16x16x32_bf16 v[20:23], v[68:71], v[76:79], v[20:23]
    ds_read_b128 v[96:99], v157 offset:38912
    v_mfma_f32_16x16x32_bf16 v[36:39], v[68:71], v[80:83], v[36:39]
    v_cos_f32 v180, v4
    v_sin_f32 v181, v4
    v_mfma_f32_16x16x32_bf16 v[24:27], v[72:75], v[76:79], v[24:27]
    v_mul_f32 v180, v180, v3
    v_mul_f32 v181, v181, v3
    v_mfma_f32_16x16x32_bf16 v[40:43], v[72:75], v[80:83], v[40:43]
    v_mul_f32 v5, 0x41000000, v5
    s_barrier
    ds_read_b128 v[76:79], v160 offset:16384
    s_waitcnt lgkmcnt(3)
    v_mfma_f32_16x16x32_bf16 v[12:15], v[84:87], v[100:103], v[12:15]
    ds_read_b128 v[60:63], v156 offset:40960
    v_mfma_f32_16x16x32_bf16 v[28:31], v[84:87], v[104:107], v[28:31]
    v_mul_f32 v3, v5, v171
    ds_read_b128 v[80:83], v160 offset:24576
    v_mfma_f32_16x16x32_bf16 v[16:19], v[88:91], v[100:103], v[16:19]
    v_mul_f32 v4, v5, v172
    ds_read_b128 v[64:67], v156 offset:43008
    v_mfma_f32_16x16x32_bf16 v[32:35], v[88:91], v[104:107], v[32:35]
    v_exp_f32 v3, v3
    ds_read_b128 v[68:71], v156 offset:45056
    s_waitcnt lgkmcnt(5)
    v_mfma_f32_16x16x32_bf16 v[20:23], v[92:95], v[100:103], v[20:23]
    ds_read_b128 v[72:75], v156 offset:47104
    v_mfma_f32_16x16x32_bf16 v[36:39], v[92:95], v[104:107], v[36:39]
    v_fract_f32 v4, v4
    v_mfma_f32_16x16x32_bf16 v[24:27], v[96:99], v[100:103], v[24:27]
    v_cos_f32 v184, v4
    v_mfma_f32_16x16x32_bf16 v[40:43], v[96:99], v[104:107], v[40:43]
    v_sin_f32 v185, v4
    ds_read_b128 v[100:103], v161 offset:16384
    s_waitcnt lgkmcnt(3)
    v_mfma_f32_16x16x32_bf16 v[12:15], v[60:63], v[76:79], v[12:15]
    ds_read_b128 v[84:87], v157 offset:40960
    v_mfma_f32_16x16x32_bf16 v[28:31], v[60:63], v[80:83], v[28:31]
    v_mul_f32 v184, v184, v3
    ds_read_b128 v[104:107], v161 offset:24576
    v_mfma_f32_16x16x32_bf16 v[16:19], v[64:67], v[76:79], v[16:19]
    v_mul_f32 v185, v185, v3
    ds_read_b128 v[88:91], v157 offset:43008
    v_mfma_f32_16x16x32_bf16 v[32:35], v[64:67], v[80:83], v[32:35]
    v_mul_f32 v3, 0x44000000, v171
    ds_read_b128 v[92:95], v157 offset:45056
    s_waitcnt lgkmcnt(5)
    v_mfma_f32_16x16x32_bf16 v[20:23], v[68:71], v[76:79], v[20:23]
    ds_read_b128 v[96:99], v157 offset:47104
    v_mfma_f32_16x16x32_bf16 v[36:39], v[68:71], v[80:83], v[36:39]
    v_mul_f32 v4, 0x44000000, v172
    v_mfma_f32_16x16x32_bf16 v[24:27], v[72:75], v[76:79], v[24:27]
    v_exp_f32 v3, v3
    v_mfma_f32_16x16x32_bf16 v[40:43], v[72:75], v[80:83], v[40:43]
    v_fract_f32 v4, v4
    s_barrier
    ds_read_b128 v[76:79], v158 offset:0
    s_waitcnt lgkmcnt(3)
    v_mfma_f32_16x16x32_bf16 v[12:15], v[84:87], v[100:103], v[12:15]
    ds_read_b128 v[60:63], v156 offset:49152
    v_mfma_f32_16x16x32_bf16 v[28:31], v[84:87], v[104:107], v[28:31]
    v_cos_f32 v182, v4
    ds_read_b128 v[80:83], v158 offset:8192
    v_mfma_f32_16x16x32_bf16 v[16:19], v[88:91], v[100:103], v[16:19]
    v_sin_f32 v183, v4
    ds_read_b128 v[64:67], v156 offset:51200
    v_mfma_f32_16x16x32_bf16 v[32:35], v[88:91], v[104:107], v[32:35]
    v_mul_f32 v182, v182, v3
    ds_read_b128 v[68:71], v156 offset:53248
    s_waitcnt lgkmcnt(5)
    v_mfma_f32_16x16x32_bf16 v[20:23], v[92:95], v[100:103], v[20:23]
    ds_read_b128 v[72:75], v156 offset:55296
    v_mfma_f32_16x16x32_bf16 v[36:39], v[92:95], v[104:107], v[36:39]
    v_mul_f32 v183, v183, v3
    v_mfma_f32_16x16x32_bf16 v[24:27], v[96:99], v[100:103], v[24:27]
    v_mul_f32 v3, 0x42800000, v171
    v_mfma_f32_16x16x32_bf16 v[40:43], v[96:99], v[104:107], v[40:43]
    v_mul_f32 v4, 0x42800000, v172
    ds_read_b128 v[100:103], v159 offset:0
    s_waitcnt lgkmcnt(3)
    v_mfma_f32_16x16x32_bf16 v[12:15], v[60:63], v[76:79], v[12:15]
    ds_read_b128 v[84:87], v157 offset:49152
    v_mfma_f32_16x16x32_bf16 v[28:31], v[60:63], v[80:83], v[28:31]
    v_exp_f32 v3, v3
    ds_read_b128 v[104:107], v159 offset:8192
    v_mfma_f32_16x16x32_bf16 v[16:19], v[64:67], v[76:79], v[16:19]
    v_fract_f32 v4, v4
    ds_read_b128 v[88:91], v157 offset:51200
    v_mfma_f32_16x16x32_bf16 v[32:35], v[64:67], v[80:83], v[32:35]
    v_cos_f32 v186, v4
    ds_read_b128 v[92:95], v157 offset:53248
    s_waitcnt lgkmcnt(5)
    v_mfma_f32_16x16x32_bf16 v[20:23], v[68:71], v[76:79], v[20:23]
    ds_read_b128 v[96:99], v157 offset:55296
    v_mfma_f32_16x16x32_bf16 v[36:39], v[68:71], v[80:83], v[36:39]
    v_sin_f32 v187, v4
    v_mfma_f32_16x16x32_bf16 v[24:27], v[72:75], v[76:79], v[24:27]
    v_mul_f32 v186, v186, v3
    v_mfma_f32_16x16x32_bf16 v[40:43], v[72:75], v[80:83], v[40:43]
    v_mul_f32 v187, v187, v3
    s_barrier
    s_waitcnt lgkmcnt(2)
    v_mfma_f32_16x16x32_bf16 v[12:15], v[84:87], v[100:103], v[12:15]
    v_mfma_f32_16x16x32_bf16 v[28:31], v[84:87], v[104:107], v[28:31]
    v_mfma_f32_16x16x32_bf16 v[16:19], v[88:91], v[100:103], v[16:19]
    v_mfma_f32_16x16x32_bf16 v[32:35], v[88:91], v[104:107], v[32:35]
    s_waitcnt lgkmcnt(0)
    v_mfma_f32_16x16x32_bf16 v[20:23], v[92:95], v[100:103], v[20:23]
    v_mfma_f32_16x16x32_bf16 v[36:39], v[92:95], v[104:107], v[36:39]
    v_mfma_f32_16x16x32_bf16 v[24:27], v[96:99], v[100:103], v[24:27]
    v_mfma_f32_16x16x32_bf16 v[40:43], v[96:99], v[104:107], v[40:43]
    buffer_load_dwordx4 v[140:143], v223, s[36:39], 0 offen offset:0 sc1
    buffer_load_dwordx4 v[144:147], v224, s[36:39], 0 offen offset:1024 sc1
    s_nop 1
    v_fma_f32 v190, v173, v12, v13
    v_fma_f32 v191, v173, v28, v29
    v_fmac_f32 v190, v175, v28
    v_fmac_f32 v191, v174, v12
    v_fma_f32 v192, v173, v190, v14
    v_fma_f32 v193, v173, v191, v30
    v_fmac_f32 v192, v175, v191
    v_fmac_f32 v193, v174, v190
    v_fma_f32 v190, v173, v192, v15
    v_fma_f32 v191, v173, v193, v31
    v_fmac_f32 v190, v175, v193
    v_fmac_f32 v191, v174, v192
    v_fma_f32 v192, v173, v190, v16
    v_fma_f32 v193, v173, v191, v32
    v_fmac_f32 v192, v175, v191
    v_fmac_f32 v193, v174, v190
    v_fma_f32 v190, v173, v192, v17
    v_fma_f32 v191, v173, v193, v33
    v_fmac_f32 v190, v175, v193
    v_fmac_f32 v191, v174, v192
    v_fma_f32 v192, v173, v190, v18
    v_fma_f32 v193, v173, v191, v34
    v_fmac_f32 v192, v175, v191
    v_fmac_f32 v193, v174, v190
    v_fma_f32 v190, v173, v192, v19
    v_fma_f32 v191, v173, v193, v35
    v_fmac_f32 v190, v175, v193
    v_fmac_f32 v191, v174, v192
    v_fma_f32 v192, v173, v190, v20
    v_fma_f32 v193, v173, v191, v36
    v_fmac_f32 v192, v175, v191
    v_fmac_f32 v193, v174, v190
    v_fma_f32 v190, v173, v192, v21
    v_fma_f32 v191, v173, v193, v37
    v_fmac_f32 v190, v175, v193
    v_fmac_f32 v191, v174, v192
    v_fma_f32 v192, v173, v190, v22
    v_fma_f32 v193, v173, v191, v38
    v_fmac_f32 v192, v175, v191
    v_fmac_f32 v193, v174, v190
    v_fma_f32 v190, v173, v192, v23
    v_fma_f32 v191, v173, v193, v39
    v_fmac_f32 v190, v175, v193
    v_fmac_f32 v191, v174, v192
    v_fma_f32 v192, v173, v190, v24
    v_fma_f32 v193, v173, v191, v40
    v_fmac_f32 v192, v175, v191
    v_fmac_f32 v193, v174, v190
    v_fma_f32 v190, v173, v192, v25
    v_fma_f32 v191, v173, v193, v41
    v_fmac_f32 v190, v175, v193
    v_fmac_f32 v191, v174, v192
    v_fma_f32 v192, v173, v190, v26
    v_fma_f32 v193, v173, v191, v42
    v_fmac_f32 v192, v175, v191
    v_fmac_f32 v193, v174, v190
    v_fma_f32 v190, v173, v192, v27
    v_fma_f32 v191, v173, v193, v43
    v_fmac_f32 v190, v175, v193
    v_fmac_f32 v191, v174, v192
    v_mov_b32 v60, v190
    v_mov_b32 v61, v191
    v_mov_b32 v62, v190
    v_mov_b32 v63, v191
    v_cmp_lt_u32 vcc, 0, v213
    v_permlane16_swap_b32 v60, v62
    v_permlane16_swap_b32 v61, v63
    v_mov_b32 v64, v60
    v_mov_b32 v65, v61
    v_mov_b32 v66, v62
    v_mov_b32 v67, v63
    v_permlane32_swap_b32 v60, v64
    v_permlane32_swap_b32 v61, v65
    v_permlane32_swap_b32 v62, v66
    v_permlane32_swap_b32 v63, v67
    v_cndmask_b32 v188, 0, v60, vcc
    v_cndmask_b32 v189, 0, v61, vcc
    v_cmp_lt_u32 vcc, 1, v213
    v_fmac_f32 v62, v178, v188
    v_fmac_f32 v63, v178, v189
    v_fma_f32 v62, -v179, v189, v62
    v_fmac_f32 v63, v179, v188
    v_cndmask_b32 v188, v188, v62, vcc
    v_cndmask_b32 v189, v189, v63, vcc
    v_cmp_lt_u32 vcc, 2, v213
    v_fmac_f32 v64, v178, v188
    v_fmac_f32 v65, v178, v189
    v_fma_f32 v64, -v179, v189, v64
    v_fmac_f32 v65, v179, v188
    v_cndmask_b32 v188, v188, v64, vcc
    v_cndmask_b32 v189, v189, v65, vcc
    v_fmac_f32 v190, v178, v188
    v_fmac_f32 v191, v178, v189
    v_fma_f32 v190, -v179, v189, v190
    v_fmac_f32 v191, v179, v188
L_pad3:
    s_cmp_eq_u32 s51, 1
    s_cbranch_scc1 L_hopd
    v_and_b32 v190, 0xffffff00, v190
    v_or_b32 v190, v190, v196
    v_and_b32 v191, 0xffffff00, v191
    v_or_b32 v191, v191, v197
    buffer_store_dwordx2 v[190:191], v206, s[8:11], 0 offen sc1
    s_barrier
    s_cmp_lg_u32 s25, s24
    s_cbranch_scc1 L_nh
    s_add_u32 s80, s24, 64
    s_load_dword s26, s[36:37], s80 glc
L_nh:
    v_mul_f32 v3, v176, v12
    v_mul_f32 v4, v177, v12
    v_fma_f32 v12, -v177, v28, v3
    v_fma_f32 v28, v176, v28, v4
    v_mul_f32 v5, v176, v13
    v_mul_f32 v6, v177, v13
    v_fma_f32 v13, -v177, v29, v5
    v_fma_f32 v29, v176, v29, v6
    v_mul_f32 v3, v176, v14
    v_mul_f32 v4, v177, v14
    v_fma_f32 v14, -v177, v30, v3
    v_fma_f32 v30, v176, v30, v4
    v_mul_f32 v5, v176, v15
    v_mul_f32 v6, v177, v15
    v_fma_f32 v15, -v177, v31, v5
    v_fma_f32 v31, v176, v31, v6
    v_mul_f32 v3, v176, v16
    v_mul_f32 v4, v177, v16
    v_fma_f32 v16, -v177, v32, v3
    v_fma_f32 v32, v176, v32, v4
    v_mul_f32 v5, v176, v17
    v_mul_f32 v6, v177, v17
    v_fma_f32 v17, -v177, v33, v5
    v_fma_f32 v33, v176, v33, v6
    v_mul_f32 v3, v176, v18
    v_mul_f32 v4, v177, v18
    v_fma_f32 v18, -v177, v34, v3
    v_fma_f32 v34, v176, v34, v4
    v_mul_f32 v5, v176, v19
    v_mul_f32 v6, v177, v19
    v_fma_f32 v19, -v177, v35, v5
    v_fma_f32 v35, v176, v35, v6
    v_mul_f32 v3, v176, v20
    v_mul_f32 v4, v177, v20
    v_fma_f32 v20, -v177, v36, v3
    v_fma_f32 v36, v176, v36, v4
    v_mul_f32 v5, v176, v21
    v_mul_f32 v6, v177, v21
    v_fma_f32 v21, -v177, v37, v5
    v_fma_f32 v37, v176, v37, v6
    v_mul_f32 v3, v176, v22
    v_mul_f32 v4, v177, v22
    v_fma_f32 v22, -v177, v38, v3
    s_barrier
    v_fma_f32 v38, v176, v38, v4
    v_mul_f32 v5, v176, v23
    v_mul_f32 v6, v177, v23
    v_fma_f32 v23, -v177, v39, v5
    v_fma_f32 v39, v176, v39, v6
    v_mul_f32 v3, v176, v24
    v_mul_f32 v4, v177, v24
    v_fma_f32 v24, -v177, v40, v3
    v_fma_f32 v40, v176, v40, v4
    v_mul_f32 v5, v176, v25
    v_mul_f32 v6, v177, v25
    v_fma_f32 v25, -v177, v41, v5
    v_fma_f32 v41, v176, v41, v6
    v_mul_f32 v3, v176, v26
    v_mul_f32 v4, v177, v26
    v_fma_f32 v26, -v177, v42, v3
    v_fma_f32 v42, v176, v42, v4
    v_mul_f32 v5, v176, v27
    v_mul_f32 v6, v177, v27
    v_fma_f32 v27, -v177, v43, v5
    v_fma_f32 v43, v176, v43, v6
    v_mul_f32 v3, v176, v188
    v_mul_f32 v4, v177, v188
    v_fma_f32 v188, -v177, v189, v3
    v_fma_f32 v189, v176, v189, v4
    v_mul_f32 v3, v176, v180
    v_mul_f32 v4, v177, v180
    v_fma_f32 v180, -v177, v181, v3
    v_fma_f32 v181, v176, v181, v4
    s_waitcnt vmcnt(1)
L_kG:
    v_xor_b32 v140, s28, v140
    v_xor_b32 v141, s29, v141
    v_xor_b32 v142, s30, v142
    v_xor_b32 v143, s31, v143
    v_xor_b32 v144, s28, v144
    v_xor_b32 v145, s29, v145
    v_xor_b32 v146, s30, v146
    v_xor_b32 v147, s31, v147
    v_or3_b32 v3, v144, v145, v146
    v_bitop3_b32 v3, v3, v147, v225 bitop3:0xa8
    v_or3_b32 v3, v3, v140, v141
    v_or3_b32 v3, v3, v142, v143
    v_and_b32 v3, 0xff, v3
    v_cmp_ne_u32 vcc, 0, v3
    s_cmp_lg_u64 vcc, 0
    s_cbranch_scc1 L_rG
L_cG:
    s_barrier
    s_waitcnt lgkmcnt(0)
    s_xor_b32 s80, s26, s58
    s_and_b32 s80, s80, 0x7fffffff
    s_cselect_b32 s26, s58, s26
    v_mov_b32 v233, s26
    buffer_store_dword v233, off, s[36:39], s25 sc1
    buffer_load_dwordx4 v[124:127], v198, s[8:11], 0 offen sc1
    buffer_load_dwordx4 v[128:131], v199, s[8:11], 0 offen sc1
    buffer_load_dwordx4 v[132:135], v200, s[8:11], 0 offen sc1
    buffer_load_dwordx4 v[136:139], v201, s[8:11], 0 offen sc1
    v_add_f32 v140, v140, v144
    v_add_f32 v142, v142, v146
    v_add_f32 v141, v141, v145
    v_add_f32 v143, v143, v147
    v_permlane32_swap_b32 v140, v142
    s_nop 0
    v_permlane32_swap_b32 v141, v143
    v_add_f32 v140, v140, v142
    v_add_f32 v141, v141, v143
    s_nop 1
    v_permlane16_swap_b32 v140, v141
    v_add_f32 v140, v140, v141
    v_cvt_pk_bf16_f32 v140, v140, v140
    v_lshlrev_b32 v140, 16, v140
    v_mul_f32 v140, 0xbfb8aa3b, v140
    v_exp_f32 v140, v140
    s_nop 0
    v_add_f32 v140, 1.0, v140
    v_rcp_f32 v140, v140
    s_nop 0
    v_cvt_pk_bf16_f32 v140, v140, v140
    v_lshlrev_b32 v228, 16, v140
    v_sub_f32 v229, 1.0, v228
    v_cvt_pk_bf16_f32 v229, v229, v229
    v_lshlrev_b32 v229, 16, v229
    v_max_f32 v229, 0x2b800000, v229
    s_barrier
    s_load_dword s4, s[36:37], s24 glc
    v_rcp_f32 v230, v229
    v_add_f32 v140, v228, v228
    v_mul_f32 v230, v230, v140
    s_barrier
    s_waitcnt vmcnt(0)
L_kE:
    v_xor_b32 v124, s28, v124
    v_xor_b32 v125, s29, v125
    v_xor_b32 v126, s30, v126
    v_xor_b32 v127, s31, v127
    v_xor_b32 v128, s28, v128
    v_xor_b32 v129, s29, v129
    v_xor_b32 v130, s30, v130
    v_xor_b32 v131, s31, v131
    v_xor_b32 v132, s28, v132
    v_xor_b32 v133, s29, v133
    v_xor_b32 v134, s30, v134
    v_xor_b32 v135, s31, v135
    v_xor_b32 v136, s28, v136
    v_xor_b32 v137, s29, v137
    v_xor_b32 v138, s30, v138
    v_xor_b32 v139, s31, v139
    v_or3_b32 v3, v124, v125, v126
    v_bitop3_b32 v3, v3, v127, v202 bitop3:0xa8
    v_or3_b32 v4, v128, v129, v130
    v_bitop3_b32 v4, v4, v131, v203 bitop3:0xa8
    v_or3_b32 v5, v132, v133, v134
    v_bitop3_b32 v5, v5, v135, v204 bitop3:0xa8
    v_or3_b32 v6, v136, v137, v138
    v_bitop3_b32 v6, v6, v139, v205 bitop3:0xa8
    v_or3_b32 v3, v3, v4, v5
    v_or_b32 v3, v3, v6
    v_cmp_ne_u32 vcc, 0, v3
    s_cmp_lg_u64 vcc, 0
    s_cbranch_scc1 L_rE
L_cE:
    v_mov_b32 v3, v126
    v_mov_b32 v4, v127
    v_mov_b32_dpp v126, v124 row_ror:8 row_mask:0xf bank_mask:0x3
    v_mov_b32_dpp v127, v125 row_ror:8 row_mask:0xf bank_mask:0x3
    v_mov_b32_dpp v124, v3 row_ror:8 row_mask:0xf bank_mask:0xc
    v_mov_b32_dpp v125, v4 row_ror:8 row_mask:0xf bank_mask:0xc
    v_fmac_f32 v124, v186, v126
    v_fmac_f32 v125, v186, v127
    v_fma_f32 v124, -v187, v127, v124
    v_fmac_f32 v125, v187, v126
    v_mov_b32 v3, v130
    v_mov_b32 v4, v131
    v_mov_b32_dpp v130, v128 row_ror:8 row_mask:0xf bank_mask:0x3
    v_mov_b32_dpp v131, v129 row_ror:8 row_mask:0xf bank_mask:0x3
    v_mov_b32_dpp v128, v3 row_ror:8 row_mask:0xf bank_mask:0xc
    s_barrier
    s_waitcnt lgkmcnt(0)
L_kN:
    s_xor_b32 s4, s4, s58
    s_and_b32 s5, s4, 0x7fffffff
    s_cbranch_scc1 L_rN
L_cN:
    s_lshr_b32 s80, s4, 31
    s_lshl_b32 s80, s80, 13
    s_add_u32 s78, s78, s80
    v_mov_b32 v234, s80
    v_add_u32 v207, s80, v207
    v_add_u32 v208, s80, v208
    s_add_u32 s80, s78, 0
    s_load_dword s68, s[36:37], s80 glc
    s_add_u32 s80, s78, 16384
    s_load_dword s68, s[36:37], s80 glc
    s_add_u32 s80, s78, 32768
    s_load_dword s68, s[36:37], s80 glc
    s_add_u32 s80, s78, 49152
    s_load_dword s68, s[36:37], s80 glc
    s_add_u32 s80, s78, 65536
    s_load_dword s68, s[36:37], s80 glc
    s_add_u32 s80, s78, 81920
    s_load_dword s68, s[36:37], s80 glc
    v_mov_b32_dpp v129, v4 row_ror:8 row_mask:0xf bank_mask:0xc
    v_fmac_f32 v128, v186, v130
    v_fmac_f32 v129, v186, v131
    v_fma_f32 v128, -v187, v131, v128
    v_fmac_f32 v129, v187, v130
    v_mov_b32 v3, v134
    v_mov_b32 v4, v135
    v_mov_b32_dpp v134, v132 row_ror:8 row_mask:0xf bank_mask:0x3
    v_mov_b32_dpp v135, v133 row_ror:8 row_mask:0xf bank_mask:0x3
    v_mov_b32_dpp v132, v3 row_ror:8 row_mask:0xf bank_mask:0xc
    v_mov_b32_dpp v133, v4 row_ror:8 row_mask:0xf bank_mask:0xc
    v_fmac_f32 v132, v186, v134
    v_fmac_f32 v133, v186, v135
    v_fma_f32 v132, -v187, v135, v132
    v_fmac_f32 v133, v187, v134
    v_mov_b32 v3, v138
    v_mov_b32 v4, v139
    v_mov_b32_dpp v138, v136 row_ror:8 row_mask:0xf bank_mask:0x3
    v_mov_b32_dpp v139, v137 row_ror:8 row_mask:0xf bank_mask:0x3
    v_mov_b32_dpp v136, v3 row_ror:8 row_mask:0xf bank_mask:0xc
    v_mov_b32_dpp v137, v4 row_ror:8 row_mask:0xf bank_mask:0xc
    v_fmac_f32 v136, v186, v138
    v_fmac_f32 v137, v186, v139
    v_fma_f32 v136, -v187, v139, v136
    v_fmac_f32 v137, v187, v138
    v_fmac_f32 v132, v182, v136
    v_fmac_f32 v133, v182, v137
    s_barrier
    v_fma_f32 v132, -v183, v137, v132
    v_fmac_f32 v133, v183, v136
    v_fmac_f32 v128, v182, v132
    v_fmac_f32 v129, v182, v133
    v_fma_f32 v128, -v183, v133, v128
    v_fmac_f32 v129, v183, v132
    v_fmac_f32 v124, v182, v128
    v_fmac_f32 v125, v182, v129
    v_fma_f32 v124, -v183, v129, v124
    v_fmac_f32 v125, v183, v128
    v_mul_f32 v126, v184, v124
    v_mul_f32 v127, v184, v125
    v_fma_f32 v126, -v185, v125, v126
    v_fmac_f32 v127, v185, v124
    v_mov_b32 v128, v126
    v_mov_b32 v129, v127
    s_nop 0
    v_permlane16_swap_b32 v126, v128
    v_permlane16_swap_b32 v127, v129
    v_add_f32 v126, v126, v128
    v_add_f32 v127, v127, v129
    v_mov_b32 v128, v126
    v_mov_b32 v129, v127
    s_nop 0
    v_permlane32_swap_b32 v126, v128
    v_permlane32_swap_b32 v127, v129
    v_add_f32 v126, v126, v128
    v_add_f32 v127, v127, v129
    v_fmac_f32 v188, v180, v126
    v_fmac_f32 v189, v180, v127
    v_fma_f32 v188, -v181, v127, v188
    v_fmac_f32 v189, v181, v126
    v_fmac_f32 v12, v173, v188
    v_fmac_f32 v28, v173, v189
    v_fmac_f32 v12, v175, v189
    v_fmac_f32 v28, v174, v188
    v_fmac_f32 v13, v173, v12
    s_barrier
    v_fmac_f32 v29, v173, v28
    v_fmac_f32 v13, v175, v28
    v_fmac_f32 v29, v174, v12
    v_mul_f32_dpp v12, v230, v12 row_newbcast:0 row_mask:0xf bank_mask:0xf
    v_mul_f32_dpp v28, v230, -v28 row_newbcast:0 row_mask:0xf bank_mask:0xf
    v_fmac_f32 v14, v173, v13
    v_fmac_f32 v30, v173, v29
    v_fmac_f32 v14, v175, v29
    v_fmac_f32 v30, v174, v13
    v_mul_f32_dpp v13, v230, v13 row_newbcast:1 row_mask:0xf bank_mask:0xf
    v_mul_f32_dpp v29, v230, -v29 row_newbcast:1 row_mask:0xf bank_mask:0xf
    v_fmac_f32 v15, v173, v14
    v_fmac_f32 v31, v173, v30
    v_fmac_f32 v15, v175, v30
    v_fmac_f32 v31, v174, v14
    v_mul_f32_dpp v14, v230, v14 row_newbcast:2 row_mask:0xf bank_mask:0xf
    v_mul_f32_dpp v30, v230, -v30 row_newbcast:2 row_mask:0xf bank_mask:0xf
    v_fmac_f32 v16, v173, v15
    v_fmac_f32 v32, v173, v31
    v_fmac_f32 v16, v175, v31
    v_fmac_f32 v32, v174, v15
    v_mul_f32_dpp v15, v230, v15 row_newbcast:3 row_mask:0xf bank_mask:0xf
    v_mul_f32_dpp v31, v230, -v31 row_newbcast:3 row_mask:0xf bank_mask:0xf
    v_cvt_pk_bf16_f32 v60, v12, v13
    v_cvt_pk_bf16_f32 v61, v14, v15
    v_cvt_pk_bf16_f32 v68, v28, v29
    v_cvt_pk_bf16_f32 v69, v30, v31
    v_fmac_f32 v17, v173, v16
    v_fmac_f32 v33, v173, v32
    v_fmac_f32 v17, v175, v32
    v_fmac_f32 v33, v174, v16
    v_mul_f32_dpp v16, v230, v16 row_newbcast:4 row_mask:0xf bank_mask:0xf
    v_mul_f32_dpp v32, v230, -v32 row_newbcast:4 row_mask:0xf bank_mask:0xf
    v_fmac_f32 v18, v173, v17
    v_fmac_f32 v34, v173, v33
    v_fmac_f32 v18, v175, v33
    v_fmac_f32 v34, v174, v17
    s_barrier
    v_mul_f32_dpp v17, v230, v17 row_newbcast:5 row_mask:0xf bank_mask:0xf
    v_mul_f32_dpp v33, v230, -v33 row_newbcast:5 row_mask:0xf bank_mask:0xf
    v_fmac_f32 v19, v173, v18
    v_fmac_f32 v35, v173, v34
    v_fmac_f32 v19, v175, v34
    v_fmac_f32 v35, v174, v18
    v_mul_f32_dpp v18, v230, v18 row_newbcast:6 row_mask:0xf bank_mask:0xf
    v_mul_f32_dpp v34, v230, -v34 row_newbcast:6 row_mask:0xf bank_mask:0xf
    v_fmac_f32 v20, v173, v19
    v_fmac_f32 v36, v173, v35
    v_fmac_f32 v20, v175, v35
    v_fmac_f32 v36, v174, v19
    v_mul_f32_dpp v19, v230, v19 row_newbcast:7 row_mask:0xf bank_mask:0xf
    v_mul_f32_dpp v35, v230, -v35 row_newbcast:7 row_mask:0xf bank_mask:0xf
    v_cvt_pk_bf16_f32 v62, v16, v17
    v_cvt_pk_bf16_f32 v63, v18, v19
    v_cvt_pk_bf16_f32 v70, v32, v33
    v_cvt_pk_bf16_f32 v71, v34, v35
    v_fmac_f32 v21, v173, v20
    v_fmac_f32 v37, v173, v36
    v_fmac_f32 v21, v175, v36
    v_fmac_f32 v37, v174, v20
    v_mul_f32_dpp v20, v230, v20 row_newbcast:8 row_mask:0xf bank_mask:0xf
    v_mul_f32_dpp v36, v230, -v36 row_newbcast:8 row_mask:0xf bank_mask:0xf
    v_fmac_f32 v22, v173, v21
    v_fmac_f32 v38, v173, v37
    s_barrier
    v_fmac_f32 v22, v175, v37
    v_fmac_f32 v38, v174, v21
    v_mul_f32_dpp v21, v230, v21 row_newbcast:9 row_mask:0xf bank_mask:0xf
    v_mul_f32_dpp v37, v230, -v37 row_newbcast:9 row_mask:0xf bank_mask:0xf
    v_fmac_f32 v23, v173, v22
    v_fmac_f32 v39, v173, v38
    v_fmac_f32 v23, v175, v38
    v_fmac_f32 v39, v174, v22
    v_mul_f32_dpp v22, v230, v22 row_newbcast:10 row_mask:0xf bank_mask:0xf
    v_mul_f32_dpp v38, v230, -v38 row_newbcast:10 row_mask:0xf bank_mask:0xf
    v_fmac_f32 v24, v173, v23
    v_fmac_f32 v40, v173, v39
    v_fmac_f32 v24, v175, v39
    v_fmac_f32 v40, v174, v23
    v_mul_f32_dpp v23, v230, v23 row_newbcast:11 row_mask:0xf bank_mask:0xf
    v_mul_f32_dpp v39, v230, -v39 row_newbcast:11 row_mask:0xf bank_mask:0xf
    v_cvt_pk_bf16_f32 v64, v20, v21
    v_cvt_pk_bf16_f32 v65, v22, v23
    v_cvt_pk_bf16_f32 v72, v36, v37
    v_cvt_pk_bf16_f32 v73, v38, v39
    v_fmac_f32 v25, v173, v24
    v_fmac_f32 v41, v173, v40
    v_fmac_f32 v25, v175, v40
    v_fmac_f32 v41, v174, v24
    v_mul_f32_dpp v24, v230, v24 row_newbcast:12 row_mask:0xf bank_mask:0xf
    v_mul_f32_dpp v40, v230, -v40 row_newbcast:12 row_mask:0xf bank_mask:0xf
    v_fmac_f32 v26, v173, v25
    v_fmac_f32 v42, v173, v41
    v_fmac_f32 v26, v175, v41
    v_fmac_f32 v42, v174, v25
    v_mul_f32_dpp v25, v230, v25 row_newbcast:13 row_mask:0xf bank_mask:0xf
    v_mul_f32_dpp v41, v230, -v41 row_newbcast:13 row_mask:0xf bank_mask:0xf
    v_fmac_f32 v27, v173, v26
    v_fmac_f32 v43, v173, v42
    v_fmac_f32 v27, v175, v42
    v_fmac_f32 v43, v174, v26
    v_mul_f32_dpp v26, v230, v26 row_newbcast:14 row_mask:0xf bank_mask:0xf
    v_mul_f32_dpp v42, v230, -v42 row_newbcast:14 row_mask:0xf bank_mask:0xf
    v_mul_f32_dpp v27, v230, v27 row_newbcast:15 row_mask:0xf bank_mask:0xf
    v_mul_f32_dpp v43, v230, -v43 row_newbcast:15 row_mask:0xf bank_mask:0xf
    v_cvt_pk_bf16_f32 v66, v24, v25
    v_cvt_pk_bf16_f32 v67, v26, v27
    v_cvt_pk_bf16_f32 v74, v40, v41
    v_cvt_pk_bf16_f32 v75, v42, v43
    s_barrier
    ds_write_b128 v211, v[60:63] offset:32768
    ds_write_b128 v212, v[64:67] offset:32768
    ds_write_b128 v211, v[68:71] offset:40960
    ds_write_b128 v212, v[72:75] offset:40960
    ds_write_b64 v232, v[228:229] offset:57344
    ds_write_b32 v235, v234 offset:57856
    s_waitcnt lgkmcnt(0)
    s_barrier
    ds_read_b64 v[92:93], v219 offset:49152
    ds_read_b64 v[94:95], v220 offset:50176
    ds_read_b64 v[96:97], v219 offset:51200
    ds_read_b64 v[98:99], v220 offset:52224
    ds_read_b64 v[124:125], v210 offset:57344
    ds_read_b64 v[126:127], v210 offset:57600
    ds_read_b64 v[128:129], v210 offset:57376
    ds_read_b64 v[130:131], v210 offset:57632
    v_lshlrev_b32 v100, 16, v168
    v_and_b32 v101, 0xffff0000, v168
    v_lshlrev_b32 v102, 16, v169
    v_and_b32 v103, 0xffff0000, v169
    s_waitcnt lgkmcnt(7)
    v_lshlrev_b32 v3, 16, v92
    v_and_b32 v4, 0xffff0000, v92
    v_mul_f32 v3, v3, v100
    v_mul_f32 v4, v4, v101
    v_cvt_pk_bf16_f32 v3, v3, v4
    v_and_b32 v4, 0xffff0000, v3
    v_lshlrev_b32 v3, 16, v3
    s_waitcnt lgkmcnt(3)
    v_mul_f32 v108, v3, v124
    v_mul_f32 v109, v4, v124
    v_lshlrev_b32 v3, 16, v93
    v_and_b32 v4, 0xffff0000, v93
    v_mul_f32 v3, v3, v102
    v_mul_f32 v4, v4, v103
    v_cvt_pk_bf16_f32 v3, v3, v4
    v_and_b32 v4, 0xffff0000, v3
    v_lshlrev_b32 v3, 16, v3
    v_mul_f32 v110, v3, v124
    v_mul_f32 v111, v4, v124
    v_lshlrev_b32 v3, 16, v94
    v_and_b32 v4, 0xffff0000, v94
    v_mul_f32 v3, v3, v100
    v_mul_f32 v4, v4, v101
    v_cvt_pk_bf16_f32 v3, v3, v4
    v_and_b32 v4, 0xffff0000, v3
    s_barrier
    v_lshlrev_b32 v3, 16, v3
    s_waitcnt lgkmcnt(2)
    v_mul_f32 v112, v3, v126
    v_mul_f32 v113, v4, v126
    v_lshlrev_b32 v3, 16, v95
    v_and_b32 v4, 0xffff0000, v95
    v_mul_f32 v3, v3, v102
    v_mul_f32 v4, v4, v103
    v_cvt_pk_bf16_f32 v3, v3, v4
    v_and_b32 v4, 0xffff0000, v3
    v_lshlrev_b32 v3, 16, v3
    v_mul_f32 v114, v3, v126
    v_mul_f32 v115, v4, v126
    v_lshlrev_b32 v3, 16, v96
    v_and_b32 v4, 0xffff0000, v96
    v_mul_f32 v3, v3, v100
    v_mul_f32 v4, v4, v101
    v_cvt_pk_bf16_f32 v3, v3, v4
    v_and_b32 v4, 0xffff0000, v3
    v_lshlrev_b32 v3, 16, v3
    s_waitcnt lgkmcnt(1)
    v_mul_f32 v116, v3, v128
    v_mul_f32 v117, v4, v128
    v_lshlrev_b32 v3, 16, v97
    v_and_b32 v4, 0xffff0000, v97
    v_mul_f32 v3, v3, v102
    v_mul_f32 v4, v4, v103
    v_cvt_pk_bf16_f32 v3, v3, v4
    v_and_b32 v4, 0xffff0000, v3
    v_lshlrev_b32 v3, 16, v3
    v_mul_f32 v118, v3, v128
    v_mul_f32 v119, v4, v128
    v_lshlrev_b32 v3, 16, v98
    v_and_b32 v4, 0xffff0000, v98
    v_mul_f32 v3, v3, v100
    v_mul_f32 v4, v4, v101
    s_barrier
    v_cvt_pk_bf16_f32 v3, v3, v4
    v_and_b32 v4, 0xffff0000, v3
    v_lshlrev_b32 v3, 16, v3
    s_waitcnt lgkmcnt(0)
    v_mul_f32 v120, v3, v130
    v_mul_f32 v121, v4, v130
    v_lshlrev_b32 v3, 16, v99
    v_and_b32 v4, 0xffff0000, v99
    v_mul_f32 v3, v3, v102
    v_mul_f32 v4, v4, v103
    v_cvt_pk_bf16_f32 v3, v3, v4
    v_and_b32 v4, 0xffff0000, v3
    v_lshlrev_b32 v3, 16, v3
    v_mul_f32 v122, v3, v130
    v_mul_f32 v123, v4, v130
    s_barrier
    s_add_u32 s80, s78, 0
    s_load_dwordx4 s[72:75], s[36:37], s80 glc
    s_barrier
    s_waitcnt lgkmcnt(0)
L_kH0:
    s_xor_b64 s[72:73], s[72:73], s[64:65]
    s_xor_b64 s[74:75], s[74:75], s[66:67]
    s_or_b64 s[72:73], s[72:73], s[74:75]
    s_or_b32 s72, s72, s73
    s_and_b32 s72, s72, s3
    s_cbranch_scc1 L_rH0
L_cH0:
    s_add_u32 m0, s71, 0
    s_mov_b32 s81, 0
    buffer_load_dwordx4 v207, s[36:39], s81 offen offset:0 sc1 lds
    buffer_load_dwordx4 v208, s[36:39], s81 offen offset:1024 sc1 lds
    s_add_u32 s80, s78, 16384
    s_load_dwordx4 s[44:47], s[36:37], s80 glc
    s_barrier
    s_waitcnt lgkmcnt(0)
L_kH1:
    s_xor_b64 s[44:45], s[44:45], s[64:65]
    s_xor_b64 s[46:47], s[46:47], s[66:67]
    s_or_b64 s[44:45], s[44:45], s[46:47]
    s_or_b32 s44, s44, s45
    s_and_b32 s44, s44, s3
    s_cbranch_scc1 L_rH1
L_cH1:
    s_add_u32 m0, s71, 8192
    s_mov_b32 s81, 16384
    buffer_load_dwordx4 v207, s[36:39], s81 offen offset:0 sc1 lds
    buffer_load_dwordx4 v208, s[36:39], s81 offen offset:1024 sc1 lds
    s_waitcnt vmcnt(2)
    ds_read_b64 v[60:61], v214 offset:0
    ds_read_b64 v[62:63], v215 offset:0
    ds_read_b64 v[64:65], v214 offset:256
    ds_read_b64 v[66:67], v215 offset:256
    s_waitcnt lgkmcnt(0)
L_kP0:
    v_bitop3_b32 v3, v60, v62, v194 bitop3:0x7e
    v_bitop3_b32 v4, v61, v63, v195 bitop3:0x7e
    v_bitop3_b32 v5, v64, v66, v194 bitop3:0x7e
    v_bitop3_b32 v6, v65, v67, v195 bitop3:0x7e
    v_or3_b32 v3, v3, v4, v5
    v_bitop3_b32 v3, v3, v6, s3 bitop3:0xa8
    v_cmp_ne_u32 vcc, 0, v3
    s_cmp_lg_u64 vcc, 0
    s_cbranch_scc1 L_rP0
L_cP0:
    s_add_u32 s80, s78, 32768
    s_load_dwordx4 s[20:23], s[36:37], s80 glc
    v_lshl_or_b32 v44, v60, 16, s85
    v_and_or_b32 v45, v60, v216, s85
    v_lshl_or_b32 v46, v61, 16, s85
    v_and_or_b32 v47, v61, v216, s85
    v_lshl_or_b32 v48, v62, 16, s85
    v_and_or_b32 v49, v62, v216, s85
    v_lshl_or_b32 v50, v63, 16, s85
    v_and_or_b32 v51, v63, v216, s85
    v_lshl_or_b32 v52, v64, 16, s85
    v_and_or_b32 v53, v64, v216, s85
    v_lshl_or_b32 v54, v65, 16, s85
    v_and_or_b32 v55, v65, v216, s85
    v_lshl_or_b32 v56, v66, 16, s85
    v_and_or_b32 v57, v66, v216, s85
    v_lshl_or_b32 v58, v67, 16, s85
    v_and_or_b32 v59, v67, v216, s85
    s_barrier
    s_waitcnt lgkmcnt(0)
L_kH2:
    s_xor_b64 s[20:21], s[20:21], s[64:65]
    s_xor_b64 s[22:23], s[22:23], s[66:67]
    s_or_b64 s[20:21], s[20:21], s[22:23]
    s_or_b32 s20, s20, s21
    s_and_b32 s20, s20, s3
    s_cbranch_scc1 L_rH2
L_cH2:
    s_add_u32 m0, s71, 16384
    s_mov_b32 s81, 32768
    buffer_load_dwordx4 v207, s[36:39], s81 offen offset:0 sc1 lds
    buffer_load_dwordx4 v208, s[36:39], s81 offen offset:1024 sc1 lds
    s_waitcnt vmcnt(2)
    ds_read_b64 v[68:69], v214 offset:8192
    ds_read_b64 v[70:71], v215 offset:8192
    ds_read_b64 v[72:73], v214 offset:8448
    ds_read_b64 v[74:75], v215 offset:8448
    s_waitcnt lgkmcnt(0)
L_kP1:
    v_bitop3_b32 v3, v68, v70, v194 bitop3:0x7e
    v_bitop3_b32 v4, v69, v71, v195 bitop3:0x7e
    v_bitop3_b32 v5, v72, v74, v194 bitop3:0x7e
    v_bitop3_b32 v6, v73, v75, v195 bitop3:0x7e
    v_or3_b32 v3, v3, v4, v5
    v_bitop3_b32 v3, v3, v6, s3 bitop3:0xa8
    v_cmp_ne_u32 vcc, 0, v3
    s_cmp_lg_u64 vcc, 0
    s_cbranch_scc1 L_rP1
L_cP1:
    v_lshl_or_b32 v3, v68, 16, s85
    v_and_or_b32 v4, v68, v216, s85
    v_add_f32 v44, v44, v3
    v_add_f32 v45, v45, v4
    v_lshl_or_b32 v5, v69, 16, s85
    v_and_or_b32 v6, v69, v216, s85
    v_add_f32 v46, v46, v5
    v_add_f32 v47, v47, v6
    v_lshl_or_b32 v3, v70, 16, s85
    v_and_or_b32 v4, v70, v216, s85
    v_add_f32 v48, v48, v3
    v_add_f32 v49, v49, v4
    s_barrier
    s_add_u32 s80, s78, 49152
    s_load_dwordx4 s[72:75], s[36:37], s80 glc
    v_lshl_or_b32 v5, v71, 16, s85
    v_and_or_b32 v6, v71, v216, s85
    v_add_f32 v50, v50, v5
    v_add_f32 v51, v51, v6
    v_lshl_or_b32 v3, v72, 16, s85
    v_and_or_b32 v4, v72, v216, s85
    v_add_f32 v52, v52, v3
    v_add_f32 v53, v53, v4
    v_lshl_or_b32 v5, v73, 16, s85
    v_and_or_b32 v6, v73, v216, s85
    v_add_f32 v54, v54, v5
    v_add_f32 v55, v55, v6
    v_lshl_or_b32 v3, v74, 16, s85
    v_and_or_b32 v4, v74, v216, s85
    v_add_f32 v56, v56, v3
    v_add_f32 v57, v57, v4
    v_lshl_or_b32 v5, v75, 16, s85
    v_and_or_b32 v6, v75, v216, s85
    s_barrier
    s_waitcnt lgkmcnt(0)
L_kH3:
    s_xor_b64 s[72:73], s[72:73], s[64:65]
    s_xor_b64 s[74:75], s[74:75], s[66:67]
    s_or_b64 s[72:73], s[72:73], s[74:75]
    s_or_b32 s72, s72, s73
    s_and_b32 s72, s72, s3
    s_cbranch_scc1 L_rH3
L_cH3:
    s_add_u32 m0, s71, 24576
    s_mov_b32 s81, 49152
    buffer_load_dwordx4 v207, s[36:39], s81 offen offset:0 sc1 lds
    buffer_load_dwordx4 v208, s[36:39], s81 offen offset:1024 sc1 lds
    v_add_f32 v58, v58, v5
    v_add_f32 v59, v59, v6
    s_waitcnt vmcnt(2)
    ds_read_b64 v[76:77], v214 offset:16384
    ds_read_b64 v[78:79], v215 offset:16384
    ds_read_b64 v[80:81], v214 offset:16640
    ds_read_b64 v[82:83], v215 offset:16640
    s_waitcnt lgkmcnt(0)
L_kP2:
    v_bitop3_b32 v3, v76, v78, v194 bitop3:0x7e
    v_bitop3_b32 v4, v77, v79, v195 bitop3:0x7e
    v_bitop3_b32 v5, v80, v82, v194 bitop3:0x7e
    v_bitop3_b32 v6, v81, v83, v195 bitop3:0x7e
    v_or3_b32 v3, v3, v4, v5
    v_bitop3_b32 v3, v3, v6, s3 bitop3:0xa8
    v_cmp_ne_u32 vcc, 0, v3
    s_cmp_lg_u64 vcc, 0
    s_cbranch_scc1 L_rP2
L_cP2:
    v_lshl_or_b32 v3, v76, 16, s85
    v_and_or_b32 v4, v76, v216, s85
    v_add_f32 v44, v44, v3
    v_add_f32 v45, v45, v4
    v_lshl_or_b32 v5, v77, 16, s85
    v_and_or_b32 v6, v77, v216, s85
    v_add_f32 v46, v46, v5
    v_add_f32 v47, v47, v6
    v_lshl_or_b32 v3, v78, 16, s85
    v_and_or_b32 v4, v78, v216, s85
    v_add_f32 v48, v48, v3
    v_add_f32 v49, v49, v4
    v_lshl_or_b32 v5, v79, 16, s85
    v_and_or_b32 v6, v79, v216, s85
    v_add_f32 v50, v50, v5
    v_add_f32 v51, v51, v6
    v_lshl_or_b32 v3, v80, 16, s85
    v_and_or_b32 v4, v80, v216, s85
    v_add_f32 v52, v52, v3
    v_add_f32 v53, v53, v4
    v_lshl_or_b32 v5, v81, 16, s85
    v_and_or_b32 v6, v81, v216, s85
    v_add_f32 v54, v54, v5
    v_add_f32 v55, v55, v6
    v_lshl_or_b32 v3, v82, 16, s85
    v_and_or_b32 v4, v82, v216, s85
    v_add_f32 v56, v56, v3
    v_add_f32 v57, v57, v4
    v_lshl_or_b32 v5, v83, 16, s85
    v_and_or_b32 v6, v83, v216, s85
    v_add_f32 v58, v58, v5
    v_add_f32 v59, v59, v6
    v_fmac_f32 v108, v44, v125
    v_fmac_f32 v109, v45, v125
    v_fmac_f32 v110, v46, v125
    v_fmac_f32 v111, v47, v125
    v_fmac_f32 v112, v48, v127
    v_fmac_f32 v113, v49, v127
    v_fmac_f32 v114, v50, v127
    v_fmac_f32 v115, v51, v127
    v_fmac_f32 v116, v52, v129
    v_fmac_f32 v117, v53, v129
    v_fmac_f32 v118, v54, v129
    v_fmac_f32 v119, v55, v129
    v_fmac_f32 v120, v56, v131
    v_fmac_f32 v121, v57, v131
    v_fmac_f32 v122, v58, v131
    v_fmac_f32 v123, v59, v131
    s_add_u32 s80, s78, 65536
    s_load_dwordx4 s[44:47], s[36:37], s80 glc
    s_barrier
    s_waitcnt vmcnt(0)
    ds_read_b64 v[84:85], v214 offset:24576
    ds_read_b64 v[86:87], v215 offset:24576
    ds_read_b64 v[88:89], v214 offset:24832
    ds_read_b64 v[90:91], v215 offset:24832
    s_waitcnt lgkmcnt(0)
L_kH4:
    s_xor_b64 s[44:45], s[44:45], s[64:65]
    s_xor_b64 s[46:47], s[46:47], s[66:67]
    s_or_b64 s[44:45], s[44:45], s[46:47]
    s_or_b32 s44, s44, s45
    s_and_b32 s44, s44, s3
    s_cbranch_scc1 L_rH4
L_cH4:
    s_add_u32 m0, s71, 32768
    s_mov_b32 s81, 65536
    buffer_load_dwordx4 v207, s[36:39], s81 offen offset:0 sc1 lds
    buffer_load_dwordx4 v208, s[36:39], s81 offen offset:1024 sc1 lds
    s_add_u32 s80, s78, 81920
    s_load_dwordx4 s[20:23], s[36:37], s80 glc
L_kP3:
    v_bitop3_b32 v3, v84, v86, v194 bitop3:0x7e
    v_bitop3_b32 v4, v85, v87, v195 bitop3:0x7e
    v_bitop3_b32 v5, v88, v90, v194 bitop3:0x7e
    v_bitop3_b32 v6, v89, v91, v195 bitop3:0x7e
    v_or3_b32 v3, v3, v4, v5
    v_bitop3_b32 v3, v3, v6, s3 bitop3:0xa8
    v_cmp_ne_u32 vcc, 0, v3
    s_cmp_lg_u64 vcc, 0
    s_cbranch_scc1 L_rP3
L_cP3:
L_pad4:
    s_cmp_eq_u32 s51, 1
    s_cbranch_scc1 L_hopd
    v_lshl_or_b32 v3, v84, 16, s85
    v_and_or_b32 v4, v84, v216, s85
    v_fmac_f32 v108, v3, v125
    v_fmac_f32 v109, v4, v125
    v_lshl_or_b32 v5, v85, 16, s85
    v_and_or_b32 v6, v85, v216, s85
    v_fmac_f32 v110, v5, v125
    v_fmac_f32 v111, v6, v125
    v_lshl_or_b32 v3, v86, 16, s85
    v_and_or_b32 v4, v86, v216, s85
    v_fmac_f32 v112, v3, v127
    v_fmac_f32 v113, v4, v127
    v_lshl_or_b32 v5, v87, 16, s85
    v_and_or_b32 v6, v87, v216, s85
    v_fmac_f32 v114, v5, v127
    v_fmac_f32 v115, v6, v127
    v_lshl_or_b32 v3, v88, 16, s85
    v_and_or_b32 v4, v88, v216, s85
    v_fmac_f32 v116, v3, v129
    v_fmac_f32 v117, v4, v129
    v_lshl_or_b32 v5, v89, 16, s85
    v_and_or_b32 v6, v89, v216, s85
    v_fmac_f32 v118, v5, v129
    v_fmac_f32 v119, v6, v129
    v_lshl_or_b32 v3, v90, 16, s85
    v_and_or_b32 v4, v90, v216, s85
    v_fmac_f32 v120, v3, v131
    v_fmac_f32 v121, v4, v131
    v_lshl_or_b32 v5, v91, 16, s85
    v_and_or_b32 v6, v91, v216, s85
    v_fmac_f32 v122, v5, v131
    v_fmac_f32 v123, v6, v131
    s_barrier
    s_waitcnt lgkmcnt(0)
L_kH5:
    s_xor_b64 s[20:21], s[20:21], s[64:65]
    s_xor_b64 s[22:23], s[22:23], s[66:67]
    s_or_b64 s[20:21], s[20:21], s[22:23]
    s_or_b32 s20, s20, s21
    s_and_b32 s20, s20, s3
    s_cbranch_scc1 L_rH5
L_cH5:
    s_add_u32 m0, s71, 40960
    s_mov_b32 s81, 81920
    buffer_load_dwordx4 v207, s[36:39], s81 offen offset:0 sc1 lds
    buffer_load_dwordx4 v208, s[36:39], s81 offen offset:1024 sc1 lds
    s_waitcnt vmcnt(2)
    ds_read_b64 v[60:61], v214 offset:32768
    ds_read_b64 v[62:63], v215 offset:32768
    ds_read_b64 v[64:65], v214 offset:33024
    ds_read_b64 v[66:67], v215 offset:33024
    s_waitcnt lgkmcnt(0)
L_kP4:
    v_bitop3_b32 v3, v60, v62, v194 bitop3:0x7e
    v_bitop3_b32 v4, v61, v63, v195 bitop3:0x7e
    v_bitop3_b32 v5, v64, v66, v194 bitop3:0x7e
    v_bitop3_b32 v6, v65, v67, v195 bitop3:0x7e
    v_or3_b32 v3, v3, v4, v5
    v_bitop3_b32 v3, v3, v6, s3 bitop3:0xa8
    v_cmp_ne_u32 vcc, 0, v3
    s_cmp_lg_u64 vcc, 0
    s_cbranch_scc1 L_rP4
L_cP4:
    v_lshl_or_b32 v3, v60, 16, s85
    v_and_or_b32 v4, v60, v216, s85
    v_fmac_f32 v108, v3, v125
    v_fmac_f32 v109, v4, v125
    v_lshl_or_b32 v5, v61, 16, s85
    v_and_or_b32 v6, v61, v216, s85
    v_fmac_f32 v110, v5, v125
    v_fmac_f32 v111, v6, v125
    v_lshl_or_b32 v3, v62, 16, s85
    v_and_or_b32 v4, v62, v216, s85
    v_fmac_f32 v112, v3, v127
    v_fmac_f32 v113, v4, v127
    v_lshl_or_b32 v5, v63, 16, s85
    v_and_or_b32 v6, v63, v216, s85
    v_fmac_f32 v114, v5, v127
    v_fmac_f32 v115, v6, v127
    v_lshl_or_b32 v3, v64, 16, s85
    v_and_or_b32 v4, v64, v216, s85
    v_fmac_f32 v116, v3, v129
    v_fmac_f32 v117, v4, v129
    v_lshl_or_b32 v5, v65, 16, s85
    v_and_or_b32 v6, v65, v216, s85
    v_fmac_f32 v118, v5, v129
    v_fmac_f32 v119, v6, v129
    v_lshl_or_b32 v3, v66, 16, s85
    v_and_or_b32 v4, v66, v216, s85
    v_fmac_f32 v120, v3, v131
    v_fmac_f32 v121, v4, v131
    v_lshl_or_b32 v5, v67, 16, s85
    v_and_or_b32 v6, v67, v216, s85
    v_fmac_f32 v122, v5, v131
    v_fmac_f32 v123, v6, v131
    s_barrier
    ds_read_b128 v[12:15], v221 offset:0
    ds_read_b128 v[16:19], v221 offset:1024
    ds_read_b128 v[20:23], v221 offset:2048
    ds_read_b128 v[24:27], v221 offset:3072
    s_waitcnt lgkmcnt(3)
    v_fmac_f32 v108, v12, v125
    v_fmac_f32 v109, v13, v125
    v_fmac_f32 v110, v14, v125
    v_fmac_f32 v111, v15, v125
    s_waitcnt lgkmcnt(2)
    v_fmac_f32 v112, v16, v127
    v_fmac_f32 v113, v17, v127
    v_fmac_f32 v114, v18, v127
    v_fmac_f32 v115, v19, v127
    s_waitcnt lgkmcnt(1)
    v_fmac_f32 v116, v20, v129
    v_fmac_f32 v117, v21, v129
    v_fmac_f32 v118, v22, v129
    v_fmac_f32 v119, v23, v129
    s_waitcnt lgkmcnt(0)
    v_fmac_f32 v120, v24, v131
    v_fmac_f32 v121, v25, v131
    v_fmac_f32 v122, v26, v131
    v_fmac_f32 v123, v27, v131
    s_waitcnt vmcnt(0)
    ds_read_b64 v[68:69], v214 offset:40960
    ds_read_b64 v[70:71], v215 offset:40960
    ds_read_b64 v[72:73], v214 offset:41216
    ds_read_b64 v[74:75], v215 offset:41216
    s_waitcnt lgkmcnt(0)
L_kP5:
    v_bitop3_b32 v3, v68, v70, v194 bitop3:0x7e
    v_bitop3_b32 v4, v69, v71, v195 bitop3:0x7e
    v_bitop3_b32 v5, v72, v74, v194 bitop3:0x7e
    v_bitop3_b32 v6, v73, v75, v195 bitop3:0x7e
    v_or3_b32 v3, v3, v4, v5
    v_bitop3_b32 v3, v3, v6, s3 bitop3:0xa8
    v_cmp_ne_u32 vcc, 0, v3
    s_cmp_lg_u64 vcc, 0
    s_cbranch_scc1 L_rP5
L_cP5:
    v_lshl_or_b32 v3, v68, 16, s85
    v_and_or_b32 v4, v68, v216, s85
    v_fmac_f32 v108, v3, v125
    v_fmac_f32 v109, v4, v125
    v_lshl_or_b32 v5, v69, 16, s85
    v_and_or_b32 v6, v69, v216, s85
    v_fmac_f32 v110, v5, v125
    v_fmac_f32 v111, v6, v125
    s_mov_b32 s79, 0
    buffer_store_dwordx4 v[108:111], v209, s[40:43], s79 offen sc1
    v_lshl_or_b32 v3, v70, 16, s85
    v_and_or_b32 v4, v70, v216, s85
    v_fmac_f32 v112, v3, v127
    v_fmac_f32 v113, v4, v127
    v_lshl_or_b32 v5, v71, 16, s85
    v_and_or_b32 v6, v71, v216, s85
    v_fmac_f32 v114, v5, v127
    v_fmac_f32 v115, v6, v127
    s_mov_b32 s79, 57344
    buffer_store_dwordx4 v[112:115], v209, s[40:43], s79 offen sc1
    v_lshl_or_b32 v3, v72, 16, s85
    v_and_or_b32 v4, v72, v216, s85
    v_fmac_f32 v116, v3, v129
    v_fmac_f32 v117, v4, v129
    v_lshl_or_b32 v5, v73, 16, s85
    v_and_or_b32 v6, v73, v216, s85
    v_fmac_f32 v118, v5, v129
    v_fmac_f32 v119, v6, v129
    s_mov_b32 s79, 7168
    buffer_store_dwordx4 v[116:119], v209, s[40:43], s79 offen sc1
    v_lshl_or_b32 v3, v74, 16, s85
    v_and_or_b32 v4, v74, v216, s85
    v_fmac_f32 v120, v3, v131
    v_fmac_f32 v121, v4, v131
    v_lshl_or_b32 v5, v75, 16, s85
    v_and_or_b32 v6, v75, v216, s85
    v_fmac_f32 v122, v5, v131
    v_fmac_f32 v123, v6, v131
    s_mov_b32 s79, 64512
    buffer_store_dwordx4 v[120:123], v209, s[40:43], s79 offen sc1
    s_lshl_b32 s79, s61, 5
    s_add_u32 s79, s79, s60
    s_add_u32 s79, s79, s71
    s_cmp_lg_u32 s79, 31
    s_cbranch_scc1 L_noep
    buffer_store_dword v170, v235, s[36:39], 0 offen sc1
L_noep:
    s_endpgm
.p2align 6
L_pad5:
    s_branch L_hopd
L_rG:
    s_sub_u32 s82, s82, 1
    s_cbranch_scc1 L_toG
    buffer_load_dwordx4 v[140:143], v223, s[36:39], 0 offen offset:0 sc1
    buffer_load_dwordx4 v[144:147], v224, s[36:39], 0 offen offset:1024 sc1
    s_waitcnt vmcnt(0)
    s_branch L_kG
L_toG:
    s_mov_b32 s82, 0
    s_branch L_cG
L_rE:
    s_sub_u32 s82, s82, 1
    s_cbranch_scc1 L_toE
    buffer_load_dwordx4 v[124:127], v198, s[8:11], 0 offen sc1
    buffer_load_dwordx4 v[128:131], v199, s[8:11], 0 offen sc1
    buffer_load_dwordx4 v[132:135], v200, s[8:11], 0 offen sc1
    buffer_load_dwordx4 v[136:139], v201, s[8:11], 0 offen sc1
    s_waitcnt vmcnt(0)
    s_branch L_kE
L_toE:
    s_mov_b32 s82, 0
    s_branch L_cE
L_rN:
    s_sub_u32 s82, s82, 1
    s_cbranch_scc1 L_toN
    s_load_dword s4, s[36:37], s24 glc
    s_waitcnt lgkmcnt(0)
    s_branch L_kN
L_toN:
    s_mov_b32 s82, 0
    s_branch L_cN
L_rH0:
    s_sub_u32 s82, s82, 1
    s_cbranch_scc1 L_toH0
    s_add_u32 s80, s78, 0
    s_load_dwordx4 s[72:75], s[36:37], s80 glc
    s_waitcnt lgkmcnt(0)
    s_branch L_kH0
L_toH0:
    s_mov_b32 s82, 0
    s_branch L_cH0
L_rH1:
    s_sub_u32 s82, s82, 1
    s_cbranch_scc1 L_toH1
    s_add_u32 s80, s78, 16384
    s_load_dwordx4 s[44:47], s[36:37], s80 glc
    s_waitcnt lgkmcnt(0)
    s_branch L_kH1
L_toH1:
    s_mov_b32 s82, 0
    s_branch L_cH1
L_rP0:
    s_sub_u32 s82, s82, 1
    s_cbranch_scc1 L_toP0
    s_add_u32 m0, s71, 0
    s_mov_b32 s81, 0
    buffer_load_dwordx4 v207, s[36:39], s81 offen offset:0 sc1 lds
    buffer_load_dwordx4 v208, s[36:39], s81 offen offset:1024 sc1 lds
    s_waitcnt vmcnt(0)
    ds_read_b64 v[60:61], v214 offset:0
    ds_read_b64 v[62:63], v215 offset:0
    ds_read_b64 v[64:65], v214 offset:256
    ds_read_b64 v[66:67], v215 offset:256
    s_waitcnt lgkmcnt(0)
    s_branch L_kP0
L_toP0:
    s_mov_b32 s82, 0
    s_branch L_cP0
L_rH2:
    s_sub_u32 s82, s82, 1
    s_cbranch_scc1 L_toH2
    s_add_u32 s80, s78, 32768
    s_load_dwordx4 s[20:23], s[36:37], s80 glc
    s_waitcnt lgkmcnt(0)
    s_branch L_kH2
L_toH2:
    s_mov_b32 s82, 0
    s_branch L_cH2
L_rP1:
    s_sub_u32 s82, s82, 1
    s_cbranch_scc1 L_toP1
    s_add_u32 m0, s71, 8192
    s_mov_b32 s81, 16384
    buffer_load_dwordx4 v207, s[36:39], s81 offen offset:0 sc1 lds
    buffer_load_dwordx4 v208, s[36:39], s81 offen offset:1024 sc1 lds
    s_waitcnt vmcnt(0)
    ds_read_b64 v[68:69], v214 offset:8192
    ds_read_b64 v[70:71], v215 offset:8192
    ds_read_b64 v[72:73], v214 offset:8448
    ds_read_b64 v[74:75], v215 offset:8448
    s_waitcnt lgkmcnt(0)
    s_branch L_kP1
L_toP1:
    s_mov_b32 s82, 0
    s_branch L_cP1
L_rH3:
    s_sub_u32 s82, s82, 1
    s_cbranch_scc1 L_toH3
    s_add_u32 s80, s78, 49152
    s_load_dwordx4 s[72:75], s[36:37], s80 glc
    s_waitcnt lgkmcnt(0)
    s_branch L_kH3
L_toH3:
    s_mov_b32 s82, 0
    s_branch L_cH3
L_rP2:
    s_sub_u32 s82, s82, 1
    s_cbranch_scc1 L_toP2
    s_add_u32 m0, s71, 16384
    s_mov_b32 s81, 32768
    buffer_load_dwordx4 v207, s[36:39], s81 offen offset:0 sc1 lds
    buffer_load_dwordx4 v208, s[36:39], s81 offen offset:1024 sc1 lds
    s_waitcnt vmcnt(0)
    ds_read_b64 v[76:77], v214 offset:16384
    ds_read_b64 v[78:79], v215 offset:16384
    ds_read_b64 v[80:81], v214 offset:16640
    ds_read_b64 v[82:83], v215 offset:16640
    s_waitcnt lgkmcnt(0)
    s_branch L_kP2
L_toP2:
    s_mov_b32 s82, 0
    s_branch L_cP2
L_rH4:
    s_sub_u32 s82, s82, 1
    s_cbranch_scc1 L_toH4
    s_add_u32 s80, s78, 65536
    s_load_dwordx4 s[44:47], s[36:37], s80 glc
    s_waitcnt lgkmcnt(0)
    s_branch L_kH4
L_toH4:
    s_mov_b32 s82, 0
    s_branch L_cH4
L_rP3:
    s_sub_u32 s82, s82, 1
    s_cbranch_scc1 L_toP3
    s_add_u32 m0, s71, 24576
    s_mov_b32 s81, 49152
    buffer_load_dwordx4 v207, s[36:39], s81 offen offset:0 sc1 lds
    buffer_load_dwordx4 v208, s[36:39], s81 offen offset:1024 sc1 lds
    s_waitcnt vmcnt(0)
    ds_read_b64 v[84:85], v214 offset:24576
    ds_read_b64 v[86:87], v215 offset:24576
    ds_read_b64 v[88:89], v214 offset:24832
    ds_read_b64 v[90:91], v215 offset:24832
    s_waitcnt lgkmcnt(0)
    s_branch L_kP3
L_toP3:
    s_mov_b32 s82, 0
    s_branch L_cP3
L_rH5:
    s_sub_u32 s82, s82, 1
    s_cbranch_scc1 L_toH5
    s_add_u32 s80, s78, 81920
    s_load_dwordx4 s[20:23], s[36:37], s80 glc
    s_waitcnt lgkmcnt(0)
    s_branch L_kH5
L_toH5:
    s_mov_b32 s82, 0
    s_branch L_cH5
L_rP4:
    s_sub_u32 s82, s82, 1
    s_cbranch_scc1 L_toP4
    s_add_u32 m0, s71, 32768
    s_mov_b32 s81, 65536
    buffer_load_dwordx4 v207, s[36:39], s81 offen offset:0 sc1 lds
    buffer_load_dwordx4 v208, s[36:39], s81 offen offset:1024 sc1 lds
    s_waitcnt vmcnt(0)
    ds_read_b64 v[60:61], v214 offset:32768
    ds_read_b64 v[62:63], v215 offset:32768
    ds_read_b64 v[64:65], v214 offset:33024
    ds_read_b64 v[66:67], v215 offset:33024
    s_waitcnt lgkmcnt(0)
    s_branch L_kP4
L_toP4:
    s_mov_b32 s82, 0
    s_branch L_cP4
L_rP5:
    s_sub_u32 s82, s82, 1
    s_cbranch_scc1 L_toP5
    s_add_u32 m0, s71, 40960
    s_mov_b32 s81, 81920
    buffer_load_dwordx4 v207, s[36:39], s81 offen offset:0 sc1 lds
    buffer_load_dwordx4 v208, s[36:39], s81 offen offset:1024 sc1 lds
    s_waitcnt vmcnt(0)
    ds_read_b64 v[68:69], v214 offset:40960
    ds_read_b64 v[70:71], v215 offset:40960
    ds_read_b64 v[72:73], v214 offset:41216
    ds_read_b64 v[74:75], v215 offset:41216
    s_waitcnt lgkmcnt(0)
    s_branch L_kP5
L_toP5:
    s_mov_b32 s82, 0
    s_branch L_cP5
L_end:
.section .rodata,"a"
.p2align 6
.amdhsa_kernel gated_mix__ssm_conv_s5__dense_activation_relu__prompt_kernel
  .amdhsa_next_free_vgpr 256
  .amdhsa_next_free_sgpr 102
  .amdhsa_accum_offset 256
  .amdhsa_group_segment_fixed_size 0
  .amdhsa_kernarg_size 128
  .amdhsa_user_sgpr_count 2
  .amdhsa_user_sgpr_kernarg_segment_ptr 1
  .amdhsa_system_sgpr_workgroup_id_x 1
.end_amdhsa_kernel
```
